```python
import torch

def _softmax(x, axis=-1):
    return torch.softmax(x, dim=axis)
def _gelu(x):
    return torch.nn.functional.gelu(x, approximate="tanh")
def _silu(x):
    return torch.nn.functional.silu(x)
def _sigmoid(x):
    return torch.sigmoid(x)
def _layernorm(x, axis=-1, eps=1e-5):
    m = x.mean(dim=axis, keepdim=True)
    v = x.var(dim=axis, keepdim=True, unbiased=False)
    return (x - m) / torch.sqrt(v + eps)
def _scatter_add(tgt, idx, src, axis=0):
    return tgt.clone().index_add_(axis, idx, src)
def _segment_sum(src, seg, n):
    out = torch.zeros((n,) + src.shape[1:], dtype=src.dtype)
    return out.index_add_(0, seg, src)
def _pad(x, pw):
    flat = tuple(v for pair in reversed(pw) for v in pair)
    return torch.nn.functional.pad(x, flat)

kernel_name = 'interleave_layers__linear_attn_block__mixer_channel_mlp__prompt'

def setup_inputs():

    _w = (lambda a: (lambda t: t.to(torch.bfloat16) if t.is_floating_point() else t)(torch.as_tensor(a)))
    def _A_setup():
        B, S, D = 1, 2048, 512
        return {
            "x": _w((lambda *s: torch.randn(*s, dtype=torch.bfloat16) * 0.05)(B, S, D)),
            "wqkv": _w((lambda *s: torch.randn(*s, dtype=torch.bfloat16) * 0.1)(D, 3 * D)),
            "wo": _w((lambda *s: torch.randn(*s, dtype=torch.bfloat16) * 0.05)(D, D)),
        }
    _A_in = _A_setup()

    def _B_setup():
        B, S, D, F = 1, 2048, 512, 1792
        return {
            "x": _w((lambda *s: torch.randn(*s, dtype=torch.bfloat16) * 0.05)(B, S, D)),
            "w1": _w((lambda *s: torch.randn(*s, dtype=torch.bfloat16) * 3.2)(D, F) * (D ** -0.5)),
            "b1": _w((lambda *s: torch.randn(*s, dtype=torch.bfloat16) * 0.8)(F)),
            "w2": _w((lambda *s: torch.randn(*s, dtype=torch.bfloat16) * 0.8)(F, D) * (F ** -0.5)),
            "b2": _w((lambda *s: torch.randn(*s, dtype=torch.bfloat16) * 0.8)(D)),
        }
    _B_in = _B_setup()

    return {
        "A_x": _A_in["x"],
        "A_wqkv": _A_in["wqkv"],
        "A_wo": _A_in["wo"],
        "B_x": _B_in["x"],
        "B_w1": _B_in["w1"],
        "B_b1": _B_in["b1"],
        "B_w2": _B_in["w2"],
        "B_b2": _B_in["b2"],
    }

def reference(A_x, A_wqkv, A_wo, B_x, B_w1, B_b1, B_w2, B_b2):
    def _A_ref(x, wqkv, wo):
        B, S, D = x.shape
        H = 32; Dh = D // H
        qkv = (lambda x, *d: x.permute(*d))((x @ wqkv).reshape(B, S, 3, H, Dh), 2, 0, 3, 1, 4)
        q, k, v = qkv[0], qkv[1], qkv[2]
        phi = lambda t: torch.where(t > 0, t + 1, torch.exp(t)) + 1e-6
        pq, pk = phi(q), phi(k)
        kv = torch.einsum("bhsd,bhse->bhde", pk, v)
        z = torch.einsum("bhsd->bhd", pk)
        num = torch.einsum("bhqd,bhde->bhqe", pq, kv)
        den = torch.einsum("bhqd,bhd->bhq", pq, z)[..., None] + 1e-6
        o = num / den
        return (lambda x, *d: x.permute(*d))(o, 0, 2, 1, 3).reshape(B, S, D) @ wo

    def _B_ref(x, w1, b1, w2, b2):
        y = _layernorm(x, axis=-1)
        h = _gelu(torch.einsum("bsd,df->bsf", y, w1) + b1)
        return torch.einsum("bsf,fd->bsd", h, w2) + b2

    x = A_x
    x = x + _A_ref(_layernorm(x, axis=-1), A_wqkv, A_wo)
    x = x + _B_ref(_layernorm(x, axis=-1), B_w1, B_b1, B_w2, B_b2)
    x = x + _A_ref(_layernorm(x, axis=-1), A_wqkv, A_wo)
    x = x + _B_ref(_layernorm(x, axis=-1), B_w1, B_b1, B_w2, B_b2)
    return x
```

```asm
; @launch grid=(256,1,1) block=(256,1,1) lds=163840
.amdgcn_target "amdgcn-amd-amdhsa--gfx950"
.text
.globl interleave_layers__linear_attn_block__mixer_channel_mlp__prompt_kernel
.p2align 8
.type interleave_layers__linear_attn_block__mixer_channel_mlp__prompt_kernel,@function
interleave_layers__linear_attn_block__mixer_channel_mlp__prompt_kernel:
  s_load_dwordx2 s[8:9], s[0:1], 8
  s_load_dwordx2 s[4:5], s[0:1], 0
  v_readfirstlane_b32 s50, v0
  s_cmp_ge_u32 s2, 256
  s_cbranch_scc1 END
  v_and_b32 v0, 63, v0
  v_lshlrev_b32 v1, 4, v0
  v_and_b32 v25, 48, v1
  v_lshrrev_b32 v26, 2, v0
  s_lshr_b32 s50, s50, 6
  s_bfe_u32 s49, s2, 0x40003
  s_and_b32 s56, s2, 7
  s_lshr_b32 s58, s2, 7
  s_mov_b32 s11, 0x20000
  s_sub_u32 s67, s50, 1
  s_cbranch_scc1 XLD
  v_mul_u32_u24 v4, 3072, v26
  v_add_u32 v4, v4, v25
  s_lshl_b32 s52, s67, 15
  s_cmp_eq_u32 s50, 3
  s_cselect_b32 s3, 0, s50
  s_lshl4_add_u32 s3, s3, s49
  s_lshl_b32 s3, s3, 6
  s_and_b32 s65, s2, 15
  s_lshl4_add_u32 s65, s58, s65
  s_mov_b32 s10, 1572864
  s_waitcnt lgkmcnt(0)
  s_mov_b32 s61, 8
L1:
  s_lshl_b32 s64, s65, 10
  s_add_u32 m0, s52, s64
  s_mul_i32 s64, s65, 49152
  s_add_u32 s64, s64, s3
  s_add_u32 s65, s65, 1
  buffer_load_dwordx4 v4, s[8:11], s64 offen lds
  s_and_b32 s65, s65, 31
  s_sub_u32 s61, s61, 1
  s_cmp_lg_u32 s61, 0
  s_cbranch_scc1 L1
  s_branch SETUP
XLD:
  v_lshrrev_b32 v24, 5, v0
  v_and_b32 v7, 0x1f0, v1
  v_lshlrev_b32 v30, 6, v7
  v_lshl_or_b32 v30, v24, 4, v30
  s_lshl_b32 s69, s56, 18
  s_lshr_b32 s61, s2, 6
  s_lshl_b32 s61, s61, 16
  s_add_u32 s69, s69, s61
  s_and_b32 s61, s49, 7
  s_lshl_b32 s61, s61, 7
  s_add_u32 s69, s69, s61
  s_add_u32 s64, s69, 32768
  s_mov_b32 s6, 2097152
  s_mov_b32 s7, s11
  s_waitcnt lgkmcnt(0)
  buffer_load_dwordx4 v[32:35], v30, s[4:7], s69 offen offset:0
  buffer_load_dwordx4 v[36:39], v30, s[4:7], s69 offen offset:32
  buffer_load_dwordx4 v[40:43], v30, s[4:7], s69 offen offset:64
  buffer_load_dwordx4 v[44:47], v30, s[4:7], s69 offen offset:96
  buffer_load_dwordx4 v[48:51], v30, s[4:7], s64 offen offset:0
  buffer_load_dwordx4 v[52:55], v30, s[4:7], s64 offen offset:32
  buffer_load_dwordx4 v[56:59], v30, s[4:7], s64 offen offset:64
  buffer_load_dwordx4 v[60:63], v30, s[4:7], s64 offen offset:96
SETUP:
  s_load_dwordx16 s[80:95], s[0:1], 0
  s_load_dwordx4 s[96:99], s[0:1], 64
  s_load_dwordx2 s[54:55], s[0:1], 80
  s_lshl1_add_u32 s48, s56, s58
  s_mov_b32 s6, 2097152
  s_mov_b32 s7, s11
  s_mov_b32 s10, 1572864
  v_mul_u32_u24 v4, 3072, v26
  v_add_u32 v4, v4, v25
  v_lshrrev_b32 v24, 5, v0
  s_getreg_b32 s53, hwreg(HW_REG_XCC_ID, 0, 4)
  v_lshlrev_b32 v6, 2, v0
  v_bfe_u32 v27, v0, 2, 2
  v_lshlrev_b32 v2, 8, v24
  v_lshl_or_b32 v2, v27, 6, v2
  v_bfe_u32 v27, v0, 4, 1
  v_lshl_or_b32 v2, v27, 5, v2
  v_lshrrev_b32 v27, 1, v25
  v_or_b32 v2, v2, v27
  v_add_u32 v3, 0x10000, v2
  v_and_b32 v26, 7, v26
  v_lshl_or_b32 v25, v24, 6, v25
  v_mul_u32_u24 v5, 3584, v26
  v_add_u32 v5, v5, v25
  v_lshl_or_b32 v31, v26, 10, v25
  v_add_u32 v7, 155648, v1
  s_mov_b32 s51, 0
  s_waitcnt lgkmcnt(0)
  s_mov_b32 s12, s84
  s_mov_b32 s13, s85
  s_mov_b32 s14, 524288
  s_mov_b32 s15, 0x20000
  s_mov_b32 s16, s88
  s_mov_b32 s17, s89
  s_mov_b32 s18, 1835008
  s_mov_b32 s19, 0x20000
  s_mov_b32 s20, s92
  s_mov_b32 s21, s93
  s_mov_b32 s22, 1835008
  s_mov_b32 s23, 0x20000
  s_mov_b32 s32, s96
  s_mov_b32 s33, s97
  s_mov_b32 s34, 2097152
  s_mov_b32 s35, 0x20000
  s_mov_b32 s36, s98
  s_mov_b32 s37, s99
  s_mov_b32 s38, 256
  s_mov_b32 s39, 0x20000
  s_mov_b32 s40, s90
  s_mov_b32 s41, s91
  s_mov_b32 s42, 3584
  s_mov_b32 s43, 0x20000
  s_mov_b32 s44, s94
  s_mov_b32 s45, s95
  s_mov_b32 s46, 1024
  s_mov_b32 s47, 0x20000
  s_lshl_b32 s56, s48, 21
  s_add_u32 s24, s54, s56
  s_addc_u32 s25, s55, 0
  s_mov_b32 s26, 0x200000
  s_mov_b32 s27, 0x20000
  s_add_u32 s28, s54, 0x2000000
  s_addc_u32 s29, s55, 0
  s_mov_b32 s30, 589824
  s_mov_b32 s31, 0x20000
  s_and_b32 s87, s49, 7
  s_lshr_b32 s88, s49, 3
  s_lshr_b32 s56, s50, 1
  s_and_b32 s57, s50, 1
  s_lshl_b32 s58, s88, 1
  s_add_u32 s89, s58, s56
  s_xor_b32 s90, s89, 1
  s_lshl_b32 s59, s87, 1
  s_add_u32 s59, s59, s57
  s_lshl_b32 s60, s48, 2
  s_add_u32 s60, s60, s89
  s_lshl_b32 s60, s60, 15
  s_lshl_b32 s61, s59, 6
  s_add_u32 s68, s60, s61
  s_lshl_b32 s96, s89, 15
  s_lshl_b32 s60, s59, 11
  s_add_u32 s96, s96, s60
  s_lshl_b32 s97, s89, 12
  s_lshl_b32 s60, s87, 9
  s_lshl_b32 s61, s57, 3
  s_add_u32 s97, s97, s60
  s_add_u32 s97, s97, s61
  s_add_u32 s97, s97, 720896
  s_lshl_b32 s94, s50, 13
  s_mul_i32 s95, s50, 393216
  s_lshl_b32 s60, s49, 6
  s_add_u32 s95, s95, s60
  s_mov_b32 s82, 737280
  s_lshl_b32 s60, s49, 4
  s_lshl_b32 s61, s50, 2
  s_add_u32 s60, s60, s61
  s_add_u32 s83, s82, s60
  s_lshl_b32 s60, s50, 15
  s_lshl_b32 s61, s49, 11
  s_add_u32 s60, s60, s61
  s_add_u32 s84, s60, 131072
  s_mul_i32 s60, s50, 114688
  s_lshl_b32 s61, s49, 13
  s_add_u32 s60, s60, s61
  s_add_u32 s85, s60, 262144
  s_cmp_ge_u32 s49, 14
  s_cselect_b32 s85, 753664, s85
  s_cselect_b32 s18, 0, s18
  s_add_u32 s80, s85, 4096
  s_and_b32 s60, s48, 1
  s_mul_i32 s60, s60, 14
  s_add_u32 s60, s60, s49
  s_lshl_b32 s60, s60, 2
  s_add_u32 s60, s60, s50
  s_lshl_b32 s81, s60, 14
  s_lshl_b32 s60, s49, 4
  s_mul_i32 s86, s60, 1152
  s_mov_b32 s91, 0x3f80
  s_mov_b32 s92, 0x3f800000
  s_mov_b32 s93, 0x3f803f80
  s_mov_b32 s76, 0xffff
  s_mov_b32 s77, 0xffff
  s_mov_b32 s78, -1
  s_mov_b32 s79, 0
  s_mov_b32 s62, 0x33333333
  s_mov_b32 s63, 0
  s_lshl_b32 s60, s57, 1
  s_lshl_b32 s61, s56, 5
  s_add_u32 s60, s60, s61
  s_lshl_b64 s[70:71], s[62:63], s60
  s_mov_b32 s62, 0x3333
  s_lshl_b32 s60, s50, 4
  s_add_u32 s60, s60, s58
  s_lshl_b64 s[72:73], s[62:63], s60
  s_mul_i32 s60, s50, 28
  s_lshr_b32 s60, s60, 3
  s_lshl_b32 s60, s60, 2
  s_add_u32 s60, s60, s58
  s_lshl_b64 s[74:75], s[62:63], s60
  s_mul_i32 s66, s50, 14336
  s_add_u32 s66, s66, 98304
  s_add_u32 s59, s66, 7168
  s_and_b32 s60, s50, 1
  s_lshl_b32 s60, s60, 9
  s_add_u32 s60, s60, s66
  v_add_u32 v28, s60, v2
  s_lshl_b32 s58, s87, 7
  s_mul_i32 s57, s50, 458752
  s_add_u32 s57, s57, s58
  s_and_b32 s60, s48, 1
  s_lshl_b32 s60, s60, 1
  s_add_u32 s60, s60, s88
  s_lshl_b32 s60, s60, 1
  s_lshr_b32 s61, s48, 1
  s_add_u32 s60, s60, s61
  s_and_b32 s56, s60, 7
  s_mov_b32 s55, s56
  s_mov_b32 s54, 8
  s_or_b32 s69, s53, 0x80
  v_lshlrev_b32 v29, 3, v1
  s_cmp_lg_u32 s50, 0
  s_cbranch_scc1 WSTART
  v_mov_b32 v24, 0
  v_lshrrev_b32 v25, 4, v6
  v_lshlrev_b32 v25, 8, v25
  v_and_or_b32 v25, v6, 12, v25
  v_mov_b32 v16, -1
  v_mov_b32 v17, -1
  v_mov_b32 v18, -1
  v_mov_b32 v19, -1
  s_mul_i32 s60, s48, 1152
  s_add_u32 s60, s60, s86
  s_add_u32 s61, s60, 294912
  buffer_store_dwordx4 v[16:19], v1, s[28:31], s60 offen sc1
  buffer_store_dwordx4 v[16:19], v1, s[28:31], s61 offen sc1
  s_mov_b64 exec, 0xff
  buffer_store_dwordx4 v[16:19], v1, s[28:31], s60 offen offset:1024 sc1
  buffer_store_dwordx4 v[16:19], v1, s[28:31], s61 offen offset:1024 sc1
  s_mov_b64 exec, s[78:79]
  buffer_store_dword v24, v25, s[24:27], s83 offen sc1
  s_mov_b64 exec, -1
  s_add_u32 s62, s96, 0
  s_add_u32 s63, s97, 0
  s_waitcnt vmcnt(11)
  v_permlane32_swap_b32 v32, v34
  v_permlane32_swap_b32 v33, v35
  v_permlane32_swap_b32 v36, v38
  v_permlane32_swap_b32 v37, v39
  s_nop 1
  buffer_store_dwordx4 v[32:35], v1, s[24:27], s62 offen sc1
  buffer_store_dwordx4 v[36:39], v1, s[24:27], s62 offen offset:1024 sc1
  v_mov_b32 v24, 0
  v_mov_b32 v25, 0
  v_mov_b32 v26, 0
  v_mov_b32 v27, 0
  v_dot2c_f32_bf16 v24, s93, v32
  v_dot2c_f32_bf16 v25, v32, v32
  v_dot2c_f32_bf16 v26, s93, v33
  v_dot2c_f32_bf16 v27, v33, v33
  v_dot2c_f32_bf16 v24, s93, v34
  v_dot2c_f32_bf16 v25, v34, v34
  v_dot2c_f32_bf16 v26, s93, v35
  v_dot2c_f32_bf16 v27, v35, v35
  v_dot2c_f32_bf16 v24, s93, v36
  v_dot2c_f32_bf16 v25, v36, v36
  v_dot2c_f32_bf16 v26, s93, v37
  v_dot2c_f32_bf16 v27, v37, v37
  v_dot2c_f32_bf16 v24, s93, v38
  v_dot2c_f32_bf16 v25, v38, v38
  v_dot2c_f32_bf16 v26, s93, v39
  v_dot2c_f32_bf16 v27, v39, v39
  s_nop 2
  v_pk_add_f32 v[24:25], v[24:25], v[26:27]
  v_mov_b32 v26, v24
  v_mov_b32 v27, v25
  s_nop 0
  v_permlane32_swap_b32 v24, v26
  v_permlane32_swap_b32 v25, v27
  s_nop 1
  v_pk_add_f32 v[24:25], v[24:25], v[26:27]
  s_mov_b64 exec, s[78:79]
  buffer_store_dwordx2 v[24:25], v1, s[24:27], s63 offen sc1
  s_mov_b64 exec, -1
  s_add_u32 s62, s96, 2048
  s_add_u32 s63, s97, 8
  s_waitcnt vmcnt(12)
  v_permlane32_swap_b32 v40, v42
  v_permlane32_swap_b32 v41, v43
  v_permlane32_swap_b32 v44, v46
  v_permlane32_swap_b32 v45, v47
  s_nop 1
  buffer_store_dwordx4 v[40:43], v1, s[24:27], s62 offen sc1
  buffer_store_dwordx4 v[44:47], v1, s[24:27], s62 offen offset:1024 sc1
  v_mov_b32 v24, 0
  v_mov_b32 v25, 0
  v_mov_b32 v26, 0
  v_mov_b32 v27, 0
  v_dot2c_f32_bf16 v24, s93, v40
  v_dot2c_f32_bf16 v25, v40, v40
  v_dot2c_f32_bf16 v26, s93, v41
  v_dot2c_f32_bf16 v27, v41, v41
  v_dot2c_f32_bf16 v24, s93, v42
  v_dot2c_f32_bf16 v25, v42, v42
  v_dot2c_f32_bf16 v26, s93, v43
  v_dot2c_f32_bf16 v27, v43, v43
  v_dot2c_f32_bf16 v24, s93, v44
  v_dot2c_f32_bf16 v25, v44, v44
  v_dot2c_f32_bf16 v26, s93, v45
  v_dot2c_f32_bf16 v27, v45, v45
  v_dot2c_f32_bf16 v24, s93, v46
  v_dot2c_f32_bf16 v25, v46, v46
  v_dot2c_f32_bf16 v26, s93, v47
  v_dot2c_f32_bf16 v27, v47, v47
  s_nop 2
  v_pk_add_f32 v[24:25], v[24:25], v[26:27]
  v_mov_b32 v26, v24
  v_mov_b32 v27, v25
  s_nop 0
  v_permlane32_swap_b32 v24, v26
  v_permlane32_swap_b32 v25, v27
  s_nop 1
  v_pk_add_f32 v[24:25], v[24:25], v[26:27]
  s_mov_b64 exec, s[78:79]
  buffer_store_dwordx2 v[24:25], v1, s[24:27], s63 offen sc1
  s_mov_b64 exec, -1
  s_add_u32 s62, s96, 32768
  s_add_u32 s63, s97, 4096
  s_waitcnt vmcnt(13)
  v_permlane32_swap_b32 v48, v50
  v_permlane32_swap_b32 v49, v51
  v_permlane32_swap_b32 v52, v54
  v_permlane32_swap_b32 v53, v55
  s_nop 1
  buffer_store_dwordx4 v[48:51], v1, s[24:27], s62 offen sc1
  buffer_store_dwordx4 v[52:55], v1, s[24:27], s62 offen offset:1024 sc1
  v_mov_b32 v24, 0
  v_mov_b32 v25, 0
  v_mov_b32 v26, 0
  v_mov_b32 v27, 0
  v_dot2c_f32_bf16 v24, s93, v48
  v_dot2c_f32_bf16 v25, v48, v48
  v_dot2c_f32_bf16 v26, s93, v49
  v_dot2c_f32_bf16 v27, v49, v49
  v_dot2c_f32_bf16 v24, s93, v50
  v_dot2c_f32_bf16 v25, v50, v50
  v_dot2c_f32_bf16 v26, s93, v51
  v_dot2c_f32_bf16 v27, v51, v51
  v_dot2c_f32_bf16 v24, s93, v52
  v_dot2c_f32_bf16 v25, v52, v52
  v_dot2c_f32_bf16 v26, s93, v53
  v_dot2c_f32_bf16 v27, v53, v53
  v_dot2c_f32_bf16 v24, s93, v54
  v_dot2c_f32_bf16 v25, v54, v54
  v_dot2c_f32_bf16 v26, s93, v55
  v_dot2c_f32_bf16 v27, v55, v55
  s_nop 2
  v_pk_add_f32 v[24:25], v[24:25], v[26:27]
  v_mov_b32 v26, v24
  v_mov_b32 v27, v25
  s_nop 0
  v_permlane32_swap_b32 v24, v26
  v_permlane32_swap_b32 v25, v27
  s_nop 1
  v_pk_add_f32 v[24:25], v[24:25], v[26:27]
  s_mov_b64 exec, s[78:79]
  buffer_store_dwordx2 v[24:25], v1, s[24:27], s63 offen sc1
  s_mov_b64 exec, -1
  s_add_u32 s62, s96, 34816
  s_add_u32 s63, s97, 4104
  s_waitcnt vmcnt(14)
  v_permlane32_swap_b32 v56, v58
  v_permlane32_swap_b32 v57, v59
  v_permlane32_swap_b32 v60, v62
  v_permlane32_swap_b32 v61, v63
  s_nop 1
  buffer_store_dwordx4 v[56:59], v1, s[24:27], s62 offen sc1
  buffer_store_dwordx4 v[60:63], v1, s[24:27], s62 offen offset:1024 sc1
  v_mov_b32 v24, 0
  v_mov_b32 v25, 0
  v_mov_b32 v26, 0
  v_mov_b32 v27, 0
  v_dot2c_f32_bf16 v24, s93, v56
  v_dot2c_f32_bf16 v25, v56, v56
  v_dot2c_f32_bf16 v26, s93, v57
  v_dot2c_f32_bf16 v27, v57, v57
  v_dot2c_f32_bf16 v24, s93, v58
  v_dot2c_f32_bf16 v25, v58, v58
  v_dot2c_f32_bf16 v26, s93, v59
  v_dot2c_f32_bf16 v27, v59, v59
  v_dot2c_f32_bf16 v24, s93, v60
  v_dot2c_f32_bf16 v25, v60, v60
  v_dot2c_f32_bf16 v26, s93, v61
  v_dot2c_f32_bf16 v27, v61, v61
  v_dot2c_f32_bf16 v24, s93, v62
  v_dot2c_f32_bf16 v25, v62, v62
  v_dot2c_f32_bf16 v26, s93, v63
  v_dot2c_f32_bf16 v27, v63, v63
  s_nop 2
  v_pk_add_f32 v[24:25], v[24:25], v[26:27]
  v_mov_b32 v26, v24
  v_mov_b32 v27, v25
  s_nop 0
  v_permlane32_swap_b32 v24, v26
  v_permlane32_swap_b32 v25, v27
  s_nop 1
  v_pk_add_f32 v[24:25], v[24:25], v[26:27]
  s_mov_b64 exec, s[78:79]
  buffer_store_dwordx2 v[24:25], v1, s[24:27], s63 offen sc1
  s_mov_b64 exec, -1
  s_lshl_b32 s60, s48, 4
  s_add_u32 s60, s60, s49
  v_mov_b32 v24, s69
  s_waitcnt vmcnt(0)
  s_mov_b64 exec, 1
  buffer_store_byte v24, off, s[36:39], s60 sc0 sc1
  s_mov_b64 exec, -1
  s_branch STAGE
WSTART:
  s_cmp_lg_u32 s50, 3
  s_cbranch_scc1 NTL
  v_lshlrev_b32 v25, 11, v1
  buffer_load_dword v24, v25, s[20:23], 0 offen
  buffer_load_dword v24, v25, s[16:19], 0 offen
  buffer_load_dword v24, v25, s[32:35], 0 offen
  buffer_load_dword v24, v25, s[40:43], 0 offen
  buffer_load_dword v24, v25, s[44:47], 0 offen
NTL:
  s_lshr_b32 s60, s2, 3
  s_lshl_b32 s60, s60, 1
  s_add_u32 s60, s60, s67
  s_lshl_b32 s60, s60, 13
  s_cmp_eq_u32 s50, 3
  s_cselect_b32 s60, 0x100000, s60
  buffer_load_dword v24, v29, s[12:15], s60 offen
  s_mov_b32 s61, 24
L2:
  s_lshl_b32 s64, s65, 10
  s_add_u32 m0, s52, s64
  s_mul_i32 s64, s65, 49152
  s_add_u32 s64, s64, s3
  s_add_u32 s65, s65, 1
  buffer_load_dwordx4 v4, s[8:11], s64 offen lds
  s_and_b32 s65, s65, 31
  s_sub_u32 s61, s61, 1
  s_cmp_lg_u32 s61, 0
  s_cbranch_scc1 L2
STAGE:
  buffer_store_dwordx4 v[0:3], v1, s[24:27], s84 offen offset:0
  buffer_store_dwordx4 v[0:3], v1, s[24:27], s84 offen offset:1024
  v_xor_b32 v29, 512, v28
  s_mul_i32 s65, s55, 57344
  s_add_u32 s65, s65, s57
  s_bitcmp1_b32 s55, 0
  s_cselect_b32 s64, s59, s66
  s_mov_b32 m0, s64
  s_mov_b32 s60, s65
  s_add_u32 s61, s60, 57344
L3:
  buffer_load_dwordx4 v31, s[20:23], s60 offen  lds
  s_add_u32 m0, m0, 1024
  s_add_u32 s60, s60, 8192
  s_cmp_lg_u32 s60, s61
  s_cbranch_scc1 L3
  s_add_u32 s55, s55, 1
  s_and_b32 s55, s55, 7
  s_mul_i32 s65, s55, 57344
  s_add_u32 s65, s65, s57
  s_bitcmp1_b32 s55, 0
  s_cselect_b32 s64, s59, s66
  s_mov_b32 m0, s64
  s_mov_b32 s60, s65
  s_add_u32 s61, s60, 57344
L4:
  buffer_load_dwordx4 v31, s[20:23], s60 offen  lds
  s_add_u32 m0, m0, 1024
  s_add_u32 s60, s60, 8192
  s_cmp_lg_u32 s60, s61
  s_cbranch_scc1 L4
  s_add_u32 s55, s55, 1
  s_and_b32 s55, s55, 7
  s_cmp_eq_u32 s50, 0
  s_cbranch_scc1 NOCS
  s_lshl_b32 s60, s67, 15
  v_add_u32 v26, s60, v2
  s_lshl_b32 s67, s67, 10
  s_waitcnt vmcnt(14)
  v_mov_b32 v22, v28
  v_mov_b32 v23, v31
  v_mov_b32 v28, 0
  v_mov_b32 v29, 0
  v_mov_b32 v30, 0
  v_mov_b32 v31, 0
  v_add_u32 v27, s67, v7
  ds_read_b64_tr_b16 v[32:33], v26 offset:0
  ds_read_b64_tr_b16 v[34:35], v26 offset:512
  ds_read_b64_tr_b16 v[36:37], v26 offset:1024
  ds_read_b64_tr_b16 v[38:39], v26 offset:1536
  ds_read_b64_tr_b16 v[40:41], v26 offset:2048
  ds_read_b64_tr_b16 v[42:43], v26 offset:2560
  ds_read_b64_tr_b16 v[44:45], v26 offset:3072
  ds_read_b64_tr_b16 v[46:47], v26 offset:3584
  ds_read_b64_tr_b16 v[48:49], v26 offset:4096
  ds_read_b64_tr_b16 v[50:51], v26 offset:4608
  ds_read_b64_tr_b16 v[52:53], v26 offset:5120
  ds_read_b64_tr_b16 v[54:55], v26 offset:5632
  ds_read_b64_tr_b16 v[56:57], v26 offset:6144
  ds_read_b64_tr_b16 v[58:59], v26 offset:6656
  s_waitcnt lgkmcnt(12)
  v_dot2c_f32_bf16 v28, s93, v32
  v_dot2c_f32_bf16 v29, s93, v33
  v_dot2c_f32_bf16 v30, s93, v34
  v_dot2c_f32_bf16 v31, s93, v35
  ds_read_b64_tr_b16 v[60:61], v26 offset:7168
  ds_read_b64_tr_b16 v[62:63], v26 offset:7680
  s_waitcnt lgkmcnt(12)
  v_dot2c_f32_bf16 v28, s93, v36
  v_dot2c_f32_bf16 v29, s93, v37
  v_dot2c_f32_bf16 v30, s93, v38
  v_dot2c_f32_bf16 v31, s93, v39
  ds_read_b64_tr_b16 v[32:33], v26 offset:8192
  ds_read_b64_tr_b16 v[34:35], v26 offset:8704
  s_waitcnt lgkmcnt(12)
  v_dot2c_f32_bf16 v28, s93, v40
  v_dot2c_f32_bf16 v29, s93, v41
  v_dot2c_f32_bf16 v30, s93, v42
  v_dot2c_f32_bf16 v31, s93, v43
  ds_read_b64_tr_b16 v[36:37], v26 offset:9216
  ds_read_b64_tr_b16 v[38:39], v26 offset:9728
  s_waitcnt lgkmcnt(12)
  v_dot2c_f32_bf16 v28, s93, v44
  v_dot2c_f32_bf16 v29, s93, v45
  v_dot2c_f32_bf16 v30, s93, v46
  v_dot2c_f32_bf16 v31, s93, v47
  ds_read_b64_tr_b16 v[40:41], v26 offset:10240
  ds_read_b64_tr_b16 v[42:43], v26 offset:10752
  s_waitcnt lgkmcnt(12)
  v_dot2c_f32_bf16 v28, s93, v48
  v_dot2c_f32_bf16 v29, s93, v49
  v_dot2c_f32_bf16 v30, s93, v50
  v_dot2c_f32_bf16 v31, s93, v51
  ds_read_b64_tr_b16 v[44:45], v26 offset:11264
  ds_read_b64_tr_b16 v[46:47], v26 offset:11776
  s_waitcnt lgkmcnt(12)
  v_dot2c_f32_bf16 v28, s93, v52
  v_dot2c_f32_bf16 v29, s93, v53
  v_dot2c_f32_bf16 v30, s93, v54
  v_dot2c_f32_bf16 v31, s93, v55
  ds_read_b64_tr_b16 v[48:49], v26 offset:12288
  ds_read_b64_tr_b16 v[50:51], v26 offset:12800
  s_waitcnt lgkmcnt(12)
  v_dot2c_f32_bf16 v28, s93, v56
  v_dot2c_f32_bf16 v29, s93, v57
  v_dot2c_f32_bf16 v30, s93, v58
  v_dot2c_f32_bf16 v31, s93, v59
  ds_read_b64_tr_b16 v[52:53], v26 offset:13312
  ds_read_b64_tr_b16 v[54:55], v26 offset:13824
  s_waitcnt lgkmcnt(12)
  v_dot2c_f32_bf16 v28, s93, v60
  v_dot2c_f32_bf16 v29, s93, v61
  v_dot2c_f32_bf16 v30, s93, v62
  v_dot2c_f32_bf16 v31, s93, v63
  ds_read_b64_tr_b16 v[56:57], v26 offset:14336
  ds_read_b64_tr_b16 v[58:59], v26 offset:14848
  s_waitcnt lgkmcnt(12)
  v_dot2c_f32_bf16 v28, s93, v32
  v_dot2c_f32_bf16 v29, s93, v33
  v_dot2c_f32_bf16 v30, s93, v34
  v_dot2c_f32_bf16 v31, s93, v35
  ds_read_b64_tr_b16 v[60:61], v26 offset:15360
  ds_read_b64_tr_b16 v[62:63], v26 offset:15872
  s_waitcnt lgkmcnt(12)
  v_dot2c_f32_bf16 v28, s93, v36
  v_dot2c_f32_bf16 v29, s93, v37
  v_dot2c_f32_bf16 v30, s93, v38
  v_dot2c_f32_bf16 v31, s93, v39
  ds_read_b64_tr_b16 v[32:33], v26 offset:16384
  ds_read_b64_tr_b16 v[34:35], v26 offset:16896
  s_waitcnt lgkmcnt(12)
  v_dot2c_f32_bf16 v28, s93, v40
  v_dot2c_f32_bf16 v29, s93, v41
  v_dot2c_f32_bf16 v30, s93, v42
  v_dot2c_f32_bf16 v31, s93, v43
  ds_read_b64_tr_b16 v[36:37], v26 offset:17408
  ds_read_b64_tr_b16 v[38:39], v26 offset:17920
  s_waitcnt lgkmcnt(12)
  v_dot2c_f32_bf16 v28, s93, v44
  v_dot2c_f32_bf16 v29, s93, v45
  v_dot2c_f32_bf16 v30, s93, v46
  v_dot2c_f32_bf16 v31, s93, v47
  ds_read_b64_tr_b16 v[40:41], v26 offset:18432
  ds_read_b64_tr_b16 v[42:43], v26 offset:18944
  s_waitcnt lgkmcnt(12)
  v_dot2c_f32_bf16 v28, s93, v48
  v_dot2c_f32_bf16 v29, s93, v49
  v_dot2c_f32_bf16 v30, s93, v50
  v_dot2c_f32_bf16 v31, s93, v51
  ds_read_b64_tr_b16 v[44:45], v26 offset:19456
  ds_read_b64_tr_b16 v[46:47], v26 offset:19968
  s_waitcnt lgkmcnt(12)
  v_dot2c_f32_bf16 v28, s93, v52
  v_dot2c_f32_bf16 v29, s93, v53
  v_dot2c_f32_bf16 v30, s93, v54
  v_dot2c_f32_bf16 v31, s93, v55
  ds_read_b64_tr_b16 v[48:49], v26 offset:20480
  ds_read_b64_tr_b16 v[50:51], v26 offset:20992
  s_waitcnt lgkmcnt(12)
  v_dot2c_f32_bf16 v28, s93, v56
  v_dot2c_f32_bf16 v29, s93, v57
  v_dot2c_f32_bf16 v30, s93, v58
  v_dot2c_f32_bf16 v31, s93, v59
  ds_read_b64_tr_b16 v[52:53], v26 offset:21504
  ds_read_b64_tr_b16 v[54:55], v26 offset:22016
  s_waitcnt lgkmcnt(12)
  v_dot2c_f32_bf16 v28, s93, v60
  v_dot2c_f32_bf16 v29, s93, v61
  v_dot2c_f32_bf16 v30, s93, v62
  v_dot2c_f32_bf16 v31, s93, v63
  ds_read_b64_tr_b16 v[56:57], v26 offset:22528
  ds_read_b64_tr_b16 v[58:59], v26 offset:23040
  s_waitcnt lgkmcnt(12)
  v_dot2c_f32_bf16 v28, s93, v32
  v_dot2c_f32_bf16 v29, s93, v33
  v_dot2c_f32_bf16 v30, s93, v34
  v_dot2c_f32_bf16 v31, s93, v35
  ds_read_b64_tr_b16 v[60:61], v26 offset:23552
  ds_read_b64_tr_b16 v[62:63], v26 offset:24064
  s_waitcnt lgkmcnt(12)
  v_dot2c_f32_bf16 v28, s93, v36
  v_dot2c_f32_bf16 v29, s93, v37
  v_dot2c_f32_bf16 v30, s93, v38
  v_dot2c_f32_bf16 v31, s93, v39
  ds_read_b64_tr_b16 v[32:33], v26 offset:24576
  ds_read_b64_tr_b16 v[34:35], v26 offset:25088
  s_waitcnt lgkmcnt(12)
  v_dot2c_f32_bf16 v28, s93, v40
  v_dot2c_f32_bf16 v29, s93, v41
  v_dot2c_f32_bf16 v30, s93, v42
  v_dot2c_f32_bf16 v31, s93, v43
  ds_read_b64_tr_b16 v[36:37], v26 offset:25600
  ds_read_b64_tr_b16 v[38:39], v26 offset:26112
  s_waitcnt lgkmcnt(12)
  v_dot2c_f32_bf16 v28, s93, v44
  v_dot2c_f32_bf16 v29, s93, v45
  v_dot2c_f32_bf16 v30, s93, v46
  v_dot2c_f32_bf16 v31, s93, v47
  ds_read_b64_tr_b16 v[40:41], v26 offset:26624
  ds_read_b64_tr_b16 v[42:43], v26 offset:27136
  s_waitcnt lgkmcnt(12)
  v_dot2c_f32_bf16 v28, s93, v48
  v_dot2c_f32_bf16 v29, s93, v49
  v_dot2c_f32_bf16 v30, s93, v50
  v_dot2c_f32_bf16 v31, s93, v51
  ds_read_b64_tr_b16 v[44:45], v26 offset:27648
  ds_read_b64_tr_b16 v[46:47], v26 offset:28160
  s_waitcnt lgkmcnt(12)
  v_dot2c_f32_bf16 v28, s93, v52
  v_dot2c_f32_bf16 v29, s93, v53
  v_dot2c_f32_bf16 v30, s93, v54
  v_dot2c_f32_bf16 v31, s93, v55
  ds_read_b64_tr_b16 v[48:49], v26 offset:28672
  ds_read_b64_tr_b16 v[50:51], v26 offset:29184
  s_waitcnt lgkmcnt(12)
  v_dot2c_f32_bf16 v28, s93, v56
  v_dot2c_f32_bf16 v29, s93, v57
  v_dot2c_f32_bf16 v30, s93, v58
  v_dot2c_f32_bf16 v31, s93, v59
  ds_read_b64_tr_b16 v[52:53], v26 offset:29696
  ds_read_b64_tr_b16 v[54:55], v26 offset:30208
  s_waitcnt lgkmcnt(12)
  v_dot2c_f32_bf16 v28, s93, v60
  v_dot2c_f32_bf16 v29, s93, v61
  v_dot2c_f32_bf16 v30, s93, v62
  v_dot2c_f32_bf16 v31, s93, v63
  ds_read_b64_tr_b16 v[56:57], v26 offset:30720
  ds_read_b64_tr_b16 v[58:59], v26 offset:31232
  s_waitcnt lgkmcnt(12)
  v_dot2c_f32_bf16 v28, s93, v32
  v_dot2c_f32_bf16 v29, s93, v33
  v_dot2c_f32_bf16 v30, s93, v34
  v_dot2c_f32_bf16 v31, s93, v35
  ds_read_b64_tr_b16 v[60:61], v26 offset:31744
  ds_read_b64_tr_b16 v[62:63], v26 offset:32256
  s_waitcnt lgkmcnt(12)
  v_dot2c_f32_bf16 v28, s93, v36
  v_dot2c_f32_bf16 v29, s93, v37
  v_dot2c_f32_bf16 v30, s93, v38
  v_dot2c_f32_bf16 v31, s93, v39
  s_waitcnt lgkmcnt(10)
  v_dot2c_f32_bf16 v28, s93, v40
  v_dot2c_f32_bf16 v29, s93, v41
  v_dot2c_f32_bf16 v30, s93, v42
  v_dot2c_f32_bf16 v31, s93, v43
  s_waitcnt lgkmcnt(8)
  v_dot2c_f32_bf16 v28, s93, v44
  v_dot2c_f32_bf16 v29, s93, v45
  v_dot2c_f32_bf16 v30, s93, v46
  v_dot2c_f32_bf16 v31, s93, v47
  s_waitcnt lgkmcnt(6)
  v_dot2c_f32_bf16 v28, s93, v48
  v_dot2c_f32_bf16 v29, s93, v49
  v_dot2c_f32_bf16 v30, s93, v50
  v_dot2c_f32_bf16 v31, s93, v51
  s_waitcnt lgkmcnt(4)
  v_dot2c_f32_bf16 v28, s93, v52
  v_dot2c_f32_bf16 v29, s93, v53
  v_dot2c_f32_bf16 v30, s93, v54
  v_dot2c_f32_bf16 v31, s93, v55
  s_waitcnt lgkmcnt(2)
  v_dot2c_f32_bf16 v28, s93, v56
  v_dot2c_f32_bf16 v29, s93, v57
  v_dot2c_f32_bf16 v30, s93, v58
  v_dot2c_f32_bf16 v31, s93, v59
  s_waitcnt lgkmcnt(0)
  v_dot2c_f32_bf16 v28, s93, v60
  v_dot2c_f32_bf16 v29, s93, v61
  v_dot2c_f32_bf16 v30, s93, v62
  v_dot2c_f32_bf16 v31, s93, v63
  s_nop 2
  v_pk_add_f32 v[28:29], v[28:29], v[30:31]
  v_add_f32 v32, v28, v29
  v_mov_b32 v33, v32
  s_nop 1
  v_permlane32_swap_b32 v32, v33
  s_nop 1
  v_add_f32 v32, v32, v33
  v_cndmask_b32 v32, 0, v32, s[78:79]
  v_cvt_pk_bf16_f32 v28, v32, v32
  v_and_b32 v28, 0xffff0000, v28
  v_sub_f32 v28, v32, v28
  v_cvt_pk_bf16_f32 v28, -v32, -v28
  v_and_b32 v29, 0xffff, v28
  v_mov_b32 v31, 0
  v_mov_b32 v30, 0
  ds_write_b128 v27, v[28:31]
  s_waitcnt lgkmcnt(0)
  s_nop 0
  v_mov_b32 v28, v22
  v_mov_b32 v31, v23
  v_xor_b32 v29, 512, v22
NOCS:
  s_cmp_eq_u32 s56, 1
  s_cbranch_scc1 CH1
  s_cmp_eq_u32 s56, 2
  s_cbranch_scc1 CH2
  s_cmp_eq_u32 s56, 3
  s_cbranch_scc1 CH3
  s_cmp_eq_u32 s56, 4
  s_cbranch_scc1 CH4
  s_cmp_eq_u32 s56, 5
  s_cbranch_scc1 CH5
  s_cmp_eq_u32 s56, 6
  s_cbranch_scc1 CH6
  s_cmp_eq_u32 s56, 7
  s_cbranch_scc1 CH7
CH0:
  s_waitcnt vmcnt(7)
  ds_read_b64_tr_b16 a[0:1], v28 offset:0
  ds_read_b64_tr_b16 a[4:5], v29 offset:0
  ds_read_b64_tr_b16 a[2:3], v28 offset:1024
  ds_read_b64_tr_b16 a[6:7], v29 offset:1024
  ds_read_b64_tr_b16 a[8:9], v28 offset:2048
  ds_read_b64_tr_b16 a[12:13], v29 offset:2048
  ds_read_b64_tr_b16 a[10:11], v28 offset:3072
  ds_read_b64_tr_b16 a[14:15], v29 offset:3072
  ds_read_b64_tr_b16 a[16:17], v28 offset:4096
  ds_read_b64_tr_b16 a[20:21], v29 offset:4096
  ds_read_b64_tr_b16 a[18:19], v28 offset:5120
  ds_read_b64_tr_b16 a[22:23], v29 offset:5120
  ds_read_b64_tr_b16 a[24:25], v28 offset:6144
  ds_read_b64_tr_b16 a[28:29], v29 offset:6144
  s_mov_b32 s64, s66
  s_call_b64 s[62:63], SNEXT
CH1:
  s_waitcnt vmcnt(7)
  ds_read_b64_tr_b16 a[26:27], v28 offset:7168
  ds_read_b64_tr_b16 a[30:31], v29 offset:7168
  ds_read_b64_tr_b16 a[32:33], v28 offset:8192
  ds_read_b64_tr_b16 a[36:37], v29 offset:8192
  ds_read_b64_tr_b16 a[34:35], v28 offset:9216
  ds_read_b64_tr_b16 a[38:39], v29 offset:9216
  ds_read_b64_tr_b16 a[40:41], v28 offset:10240
  ds_read_b64_tr_b16 a[44:45], v29 offset:10240
  ds_read_b64_tr_b16 a[42:43], v28 offset:11264
  ds_read_b64_tr_b16 a[46:47], v29 offset:11264
  ds_read_b64_tr_b16 a[48:49], v28 offset:12288
  ds_read_b64_tr_b16 a[52:53], v29 offset:12288
  ds_read_b64_tr_b16 a[50:51], v28 offset:13312
  ds_read_b64_tr_b16 a[54:55], v29 offset:13312
  s_mov_b32 s64, s59
  s_call_b64 s[62:63], SNEXT
CH2:
  s_waitcnt vmcnt(7)
  ds_read_b64_tr_b16 a[56:57], v28 offset:0
  ds_read_b64_tr_b16 a[60:61], v29 offset:0
  ds_read_b64_tr_b16 a[58:59], v28 offset:1024
  ds_read_b64_tr_b16 a[62:63], v29 offset:1024
  ds_read_b64_tr_b16 a[64:65], v28 offset:2048
  ds_read_b64_tr_b16 a[68:69], v29 offset:2048
  ds_read_b64_tr_b16 a[66:67], v28 offset:3072
  ds_read_b64_tr_b16 a[70:71], v29 offset:3072
  ds_read_b64_tr_b16 a[72:73], v28 offset:4096
  ds_read_b64_tr_b16 a[76:77], v29 offset:4096
  ds_read_b64_tr_b16 a[74:75], v28 offset:5120
  ds_read_b64_tr_b16 a[78:79], v29 offset:5120
  ds_read_b64_tr_b16 a[80:81], v28 offset:6144
  ds_read_b64_tr_b16 a[84:85], v29 offset:6144
  s_mov_b32 s64, s66
  s_call_b64 s[62:63], SNEXT
CH3:
  s_waitcnt vmcnt(7)
  ds_read_b64_tr_b16 a[82:83], v28 offset:7168
  ds_read_b64_tr_b16 a[86:87], v29 offset:7168
  ds_read_b64_tr_b16 a[88:89], v28 offset:8192
  ds_read_b64_tr_b16 a[92:93], v29 offset:8192
  ds_read_b64_tr_b16 a[90:91], v28 offset:9216
  ds_read_b64_tr_b16 a[94:95], v29 offset:9216
  ds_read_b64_tr_b16 a[96:97], v28 offset:10240
  ds_read_b64_tr_b16 a[100:101], v29 offset:10240
  ds_read_b64_tr_b16 a[98:99], v28 offset:11264
  ds_read_b64_tr_b16 a[102:103], v29 offset:11264
  ds_read_b64_tr_b16 a[104:105], v28 offset:12288
  ds_read_b64_tr_b16 a[108:109], v29 offset:12288
  ds_read_b64_tr_b16 a[106:107], v28 offset:13312
  ds_read_b64_tr_b16 a[110:111], v29 offset:13312
  s_mov_b32 s64, s59
  s_call_b64 s[62:63], SNEXT
CH4:
  s_waitcnt vmcnt(7)
  ds_read_b64_tr_b16 a[112:113], v28 offset:0
  ds_read_b64_tr_b16 a[116:117], v29 offset:0
  ds_read_b64_tr_b16 a[114:115], v28 offset:1024
  ds_read_b64_tr_b16 a[118:119], v29 offset:1024
  ds_read_b64_tr_b16 a[120:121], v28 offset:2048
  ds_read_b64_tr_b16 a[124:125], v29 offset:2048
  ds_read_b64_tr_b16 a[122:123], v28 offset:3072
  ds_read_b64_tr_b16 a[126:127], v29 offset:3072
  ds_read_b64_tr_b16 a[128:129], v28 offset:4096
  ds_read_b64_tr_b16 a[132:133], v29 offset:4096
  ds_read_b64_tr_b16 a[130:131], v28 offset:5120
  ds_read_b64_tr_b16 a[134:135], v29 offset:5120
  ds_read_b64_tr_b16 a[136:137], v28 offset:6144
  ds_read_b64_tr_b16 a[140:141], v29 offset:6144
  s_mov_b32 s64, s66
  s_call_b64 s[62:63], SNEXT
CH5:
  s_waitcnt vmcnt(7)
  ds_read_b64_tr_b16 a[138:139], v28 offset:7168
  ds_read_b64_tr_b16 a[142:143], v29 offset:7168
  ds_read_b64_tr_b16 a[144:145], v28 offset:8192
  ds_read_b64_tr_b16 a[148:149], v29 offset:8192
  ds_read_b64_tr_b16 a[146:147], v28 offset:9216
  ds_read_b64_tr_b16 a[150:151], v29 offset:9216
  ds_read_b64_tr_b16 a[152:153], v28 offset:10240
  ds_read_b64_tr_b16 a[156:157], v29 offset:10240
  ds_read_b64_tr_b16 a[154:155], v28 offset:11264
  ds_read_b64_tr_b16 a[158:159], v29 offset:11264
  ds_read_b64_tr_b16 a[160:161], v28 offset:12288
  ds_read_b64_tr_b16 a[164:165], v29 offset:12288
  ds_read_b64_tr_b16 a[162:163], v28 offset:13312
  ds_read_b64_tr_b16 a[166:167], v29 offset:13312
  s_mov_b32 s64, s59
  s_call_b64 s[62:63], SNEXT
CH6:
  s_waitcnt vmcnt(7)
  ds_read_b64_tr_b16 a[168:169], v28 offset:0
  ds_read_b64_tr_b16 a[172:173], v29 offset:0
  ds_read_b64_tr_b16 a[170:171], v28 offset:1024
  ds_read_b64_tr_b16 a[174:175], v29 offset:1024
  ds_read_b64_tr_b16 a[176:177], v28 offset:2048
  ds_read_b64_tr_b16 a[180:181], v29 offset:2048
  ds_read_b64_tr_b16 a[178:179], v28 offset:3072
  ds_read_b64_tr_b16 a[182:183], v29 offset:3072
  ds_read_b64_tr_b16 a[184:185], v28 offset:4096
  ds_read_b64_tr_b16 a[188:189], v29 offset:4096
  ds_read_b64_tr_b16 a[186:187], v28 offset:5120
  ds_read_b64_tr_b16 a[190:191], v29 offset:5120
  ds_read_b64_tr_b16 a[192:193], v28 offset:6144
  ds_read_b64_tr_b16 a[196:197], v29 offset:6144
  s_mov_b32 s64, s66
  s_call_b64 s[62:63], SNEXT
CH7:
  s_waitcnt vmcnt(7)
  ds_read_b64_tr_b16 a[194:195], v28 offset:7168
  ds_read_b64_tr_b16 a[198:199], v29 offset:7168
  ds_read_b64_tr_b16 a[200:201], v28 offset:8192
  ds_read_b64_tr_b16 a[204:205], v29 offset:8192
  ds_read_b64_tr_b16 a[202:203], v28 offset:9216
  ds_read_b64_tr_b16 a[206:207], v29 offset:9216
  ds_read_b64_tr_b16 a[208:209], v28 offset:10240
  ds_read_b64_tr_b16 a[212:213], v29 offset:10240
  ds_read_b64_tr_b16 a[210:211], v28 offset:11264
  ds_read_b64_tr_b16 a[214:215], v29 offset:11264
  ds_read_b64_tr_b16 a[216:217], v28 offset:12288
  ds_read_b64_tr_b16 a[220:221], v29 offset:12288
  ds_read_b64_tr_b16 a[218:219], v28 offset:13312
  ds_read_b64_tr_b16 a[222:223], v29 offset:13312
  s_mov_b32 s64, s59
  s_call_b64 s[62:63], SNEXT
  s_branch CH0
SNEXT:
  s_sub_u32 s54, s54, 1
  s_cmp_lt_u32 s54, 2
  s_waitcnt lgkmcnt(0)
  s_cbranch_scc1 SWO
  s_mul_i32 s65, s55, 57344
  s_add_u32 s65, s65, s57
  s_add_u32 s55, s55, 1
  s_and_b32 s55, s55, 7
  s_mov_b32 m0, s64
  s_mov_b32 s60, s65
  s_add_u32 s61, s60, 57344
L5:
  buffer_load_dwordx4 v31, s[20:23], s60 offen  lds
  s_add_u32 m0, m0, 1024
  s_add_u32 s60, s60, 8192
  s_cmp_lg_u32 s60, s61
  s_cbranch_scc1 L5
  s_setpc_b64 s[62:63]
SWO:
  s_lshl_b32 s65, s50, 17
  s_add_u32 s65, s65, s58
  s_cmp_eq_u32 s54, 0
  s_cselect_b32 s60, 57344, 0
  s_add_u32 s65, s65, s60
  s_mov_b32 m0, s64
  s_mov_b32 s60, s65
  s_add_u32 s61, s60, 57344
L6:
  buffer_load_dwordx4 v31, s[12:15], s60 offen  lds
  s_add_u32 m0, m0, 1024
  s_add_u32 s60, s60, 8192
  s_cmp_lg_u32 s60, s61
  s_cbranch_scc1 L6
  s_cmp_eq_u32 s54, 0
  s_cbranch_scc1 SDONE
  s_sub_u32 s57, s64, s66
  s_setpc_b64 s[62:63]
SDONE:
  s_mov_b32 s65, s60
  s_sub_u32 s64, s64, s66
  v_add_u32 v24, s57, v28
  v_add_u32 v25, s57, v29
  v_add_u32 v26, s64, v28
  v_add_u32 v27, s64, v29
  s_add_u32 s57, s57, s66
  s_waitcnt vmcnt(7)
  ds_read_b64_tr_b16 a[224:225], v24 offset:0
  ds_read_b64_tr_b16 a[228:229], v25 offset:0
  ds_read_b64_tr_b16 a[226:227], v24 offset:1024
  ds_read_b64_tr_b16 a[230:231], v25 offset:1024
  ds_read_b64_tr_b16 a[232:233], v24 offset:2048
  ds_read_b64_tr_b16 a[236:237], v25 offset:2048
  ds_read_b64_tr_b16 a[234:235], v24 offset:3072
  ds_read_b64_tr_b16 a[238:239], v25 offset:3072
  ds_read_b64_tr_b16 a[240:241], v24 offset:4096
  ds_read_b64_tr_b16 a[244:245], v25 offset:4096
  ds_read_b64_tr_b16 a[242:243], v24 offset:5120
  ds_read_b64_tr_b16 a[246:247], v25 offset:5120
  ds_read_b64_tr_b16 a[248:249], v24 offset:6144
  ds_read_b64_tr_b16 a[252:253], v25 offset:6144
  s_waitcnt lgkmcnt(0)
  s_mov_b32 m0, s57
  s_mov_b32 s60, s65
  s_add_u32 s61, s60, 16384
L7:
  buffer_load_dwordx4 v31, s[12:15], s60 offen  lds
  s_add_u32 m0, m0, 1024
  s_add_u32 s60, s60, 8192
  s_cmp_lg_u32 s60, s61
  s_cbranch_scc1 L7
  s_waitcnt vmcnt(2)
  ds_read_b64_tr_b16 a[250:251], v26 offset:0
  ds_read_b64_tr_b16 a[254:255], v27 offset:0
  ds_read_b64_tr_b16 v[224:225], v26 offset:1024
  ds_read_b64_tr_b16 v[228:229], v27 offset:1024
  ds_read_b64_tr_b16 v[226:227], v26 offset:2048
  ds_read_b64_tr_b16 v[230:231], v27 offset:2048
  ds_read_b64_tr_b16 v[232:233], v26 offset:3072
  ds_read_b64_tr_b16 v[236:237], v27 offset:3072
  ds_read_b64_tr_b16 v[234:235], v26 offset:4096
  ds_read_b64_tr_b16 v[238:239], v27 offset:4096
  ds_read_b64_tr_b16 v[240:241], v26 offset:5120
  ds_read_b64_tr_b16 v[244:245], v27 offset:5120
  ds_read_b64_tr_b16 v[242:243], v26 offset:6144
  ds_read_b64_tr_b16 v[246:247], v27 offset:6144
  s_waitcnt vmcnt(0)
  ds_read_b64_tr_b16 v[248:249], v24 offset:0
  ds_read_b64_tr_b16 v[252:253], v25 offset:0
  ds_read_b64_tr_b16 v[250:251], v24 offset:1024
  ds_read_b64_tr_b16 v[254:255], v25 offset:1024
  s_mul_i32 s69, s69, 0x01010101
  s_mov_b32 s61, 200000
  s_lshl_b32 s60, s48, 2
  s_lshl_b64 s[64:65], 15, s60
RP:
  buffer_load_dword v24, v6, s[36:39], 0 offen sc1
  s_sub_u32 s61, s61, 1
  s_cbranch_scc1 FIN
  s_waitcnt vmcnt(0)
  v_and_b32 v25, 0x80808080, v24
  v_cmp_ne_u32 vcc, 0x80808080, v25
  s_cmp_eq_u64 vcc, 0
  s_cbranch_scc0 RP
  v_cmp_ne_u32 vcc, s69, v24
  s_and_b64 s[62:63], vcc, s[64:65]
  s_cselect_b32 s52, 1, 0
  s_barrier
LAYER:
  s_lshl_b32 s65, s50, 12
  s_add_u32 s65, s65, 720896
  s_lshl_b32 s64, s50, 15
  buffer_load_dwordx4 v[96:99], v1, s[24:27], s64 offen  sc1
  buffer_load_dwordx4 v[100:103], v1, s[24:27], s64 offen offset:1024 sc1
  buffer_load_dwordx4 v[208:211], v1, s[24:27], s65 offen  sc1
  buffer_load_dwordx4 v[212:215], v1, s[24:27], s65 offen offset:1024 sc1
  buffer_load_dwordx4 v[216:219], v1, s[24:27], s65 offen offset:2048 sc1
  buffer_load_dwordx4 v[220:223], v1, s[24:27], s65 offen offset:3072 sc1
  buffer_load_dwordx4 v[104:107], v1, s[24:27], s64 offen offset:2048 sc1
  buffer_load_dwordx4 v[108:111], v1, s[24:27], s64 offen offset:3072 sc1
  s_add_u32 s64, s64, 4096
  buffer_load_dwordx4 v[112:115], v1, s[24:27], s64 offen  sc1
  buffer_load_dwordx4 v[116:119], v1, s[24:27], s64 offen offset:1024 sc1
  buffer_load_dwordx4 v[120:123], v1, s[24:27], s64 offen offset:2048 sc1
  buffer_load_dwordx4 v[124:127], v1, s[24:27], s64 offen offset:3072 sc1
  ds_read_b64_tr_b16 v[24:25], v2 offset:0
  ds_read_b64_tr_b16 v[26:27], v2 offset:512
  ds_read_b64_tr_b16 v[28:29], v2 offset:32768
  ds_read_b64_tr_b16 v[30:31], v2 offset:33280
  ds_read_b64_tr_b16 v[80:81], v2 offset:1024
  ds_read_b64_tr_b16 v[82:83], v2 offset:1536
  ds_read_b64_tr_b16 v[84:85], v2 offset:33792
  ds_read_b64_tr_b16 v[86:87], v2 offset:34304
  ds_read_b64_tr_b16 v[88:89], v2 offset:2048
  ds_read_b64_tr_b16 v[90:91], v2 offset:2560
  ds_read_b64_tr_b16 v[92:93], v2 offset:34816
  ds_read_b64_tr_b16 v[94:95], v2 offset:35328
  s_waitcnt lgkmcnt(8) vmcnt(11)
  v_mfma_f32_32x32x16_bf16 v[32:47], v[96:99], v[24:27], 0
  ds_read_b64_tr_b16 v[16:17], v2 offset:3072
  ds_read_b64_tr_b16 v[18:19], v2 offset:3584
  s_add_u32 s64, s64, 4096
  buffer_load_dwordx4 v[128:131], v1, s[24:27], s64 offen  sc1
  v_mfma_f32_32x32x16_bf16 v[48:63], v[96:99], v[28:31], 0
  ds_read_b64_tr_b16 v[20:21], v2 offset:35840
  ds_read_b64_tr_b16 v[22:23], v2 offset:36352
  s_waitcnt lgkmcnt(8) vmcnt(11)
  v_mfma_f32_32x32x16_bf16 v[32:47], v[100:103], v[80:83], v[32:47]
  ds_read_b64_tr_b16 v[24:25], v2 offset:4096
  ds_read_b64_tr_b16 v[26:27], v2 offset:4608
  buffer_load_dwordx4 v[132:135], v1, s[24:27], s64 offen offset:1024 sc1
  v_mfma_f32_32x32x16_bf16 v[48:63], v[100:103], v[84:87], v[48:63]
  ds_read_b64_tr_b16 v[28:29], v2 offset:36864
  ds_read_b64_tr_b16 v[30:31], v2 offset:37376
  s_waitcnt lgkmcnt(8) vmcnt(7)
  v_mfma_f32_32x32x16_bf16 v[32:47], v[104:107], v[88:91], v[32:47]
  ds_read_b64_tr_b16 v[80:81], v2 offset:5120
  ds_read_b64_tr_b16 v[82:83], v2 offset:5632
  buffer_load_dwordx4 v[136:139], v1, s[24:27], s64 offen offset:2048 sc1
  v_add_f32 v222, v222, v208
  v_mfma_f32_32x32x16_bf16 v[48:63], v[104:107], v[92:95], v[48:63]
  ds_read_b64_tr_b16 v[84:85], v2 offset:37888
  ds_read_b64_tr_b16 v[86:87], v2 offset:38400
  v_add_f32 v223, v223, v209
  v_add_f32 v222, v222, v210
  s_waitcnt lgkmcnt(8) vmcnt(7)
  v_mfma_f32_32x32x16_bf16 v[32:47], v[108:111], v[16:19], v[32:47]
  ds_read_b64_tr_b16 v[88:89], v2 offset:6144
  ds_read_b64_tr_b16 v[90:91], v2 offset:6656
  buffer_load_dwordx4 v[140:143], v1, s[24:27], s64 offen offset:3072 sc1
  v_add_f32 v223, v223, v211
  v_mfma_f32_32x32x16_bf16 v[48:63], v[108:111], v[20:23], v[48:63]
  ds_read_b64_tr_b16 v[92:93], v2 offset:38912
  ds_read_b64_tr_b16 v[94:95], v2 offset:39424
  v_add_f32 v222, v222, v212
  v_add_f32 v223, v223, v213
  s_waitcnt lgkmcnt(8) vmcnt(7)
  v_mfma_f32_32x32x16_bf16 v[32:47], v[112:115], v[24:27], v[32:47]
  ds_read_b64_tr_b16 v[16:17], v2 offset:7168
  ds_read_b64_tr_b16 v[18:19], v2 offset:7680
  s_add_u32 s64, s64, 4096
  buffer_load_dwordx4 v[144:147], v1, s[24:27], s64 offen  sc1
  v_add_f32 v222, v222, v214
  v_mfma_f32_32x32x16_bf16 v[48:63], v[112:115], v[28:31], v[48:63]
  ds_read_b64_tr_b16 v[20:21], v2 offset:39936
  ds_read_b64_tr_b16 v[22:23], v2 offset:40448
  v_add_f32 v223, v223, v215
  v_add_f32 v222, v222, v216
  s_waitcnt lgkmcnt(8) vmcnt(7)
  v_mfma_f32_32x32x16_bf16 v[32:47], v[116:119], v[80:83], v[32:47]
  ds_read_b64_tr_b16 v[24:25], v2 offset:8192
  ds_read_b64_tr_b16 v[26:27], v2 offset:8704
  buffer_load_dwordx4 v[148:151], v1, s[24:27], s64 offen offset:1024 sc1
  v_add_f32 v223, v223, v217
  v_mfma_f32_32x32x16_bf16 v[48:63], v[116:119], v[84:87], v[48:63]
  ds_read_b64_tr_b16 v[28:29], v2 offset:40960
  ds_read_b64_tr_b16 v[30:31], v2 offset:41472
  v_add_f32 v222, v222, v218
  v_add_f32 v223, v223, v219
  s_waitcnt lgkmcnt(8) vmcnt(7)
  v_mfma_f32_32x32x16_bf16 v[32:47], v[120:123], v[88:91], v[32:47]
  ds_read_b64_tr_b16 v[80:81], v2 offset:9216
  ds_read_b64_tr_b16 v[82:83], v2 offset:9728
  buffer_load_dwordx4 v[152:155], v1, s[24:27], s64 offen offset:2048 sc1
  v_add_f32 v222, v222, v220
  v_mfma_f32_32x32x16_bf16 v[48:63], v[120:123], v[92:95], v[48:63]
  ds_read_b64_tr_b16 v[84:85], v2 offset:41984
  ds_read_b64_tr_b16 v[86:87], v2 offset:42496
  v_add_f32 v223, v223, v221
  v_mov_b32 v220, v222
  s_waitcnt lgkmcnt(8) vmcnt(7)
  v_mfma_f32_32x32x16_bf16 v[32:47], v[124:127], v[16:19], v[32:47]
  ds_read_b64_tr_b16 v[88:89], v2 offset:10240
  ds_read_b64_tr_b16 v[90:91], v2 offset:10752
  buffer_load_dwordx4 v[156:159], v1, s[24:27], s64 offen offset:3072 sc1
  v_mov_b32 v221, v223
  v_mfma_f32_32x32x16_bf16 v[48:63], v[124:127], v[20:23], v[48:63]
  ds_read_b64_tr_b16 v[92:93], v2 offset:43008
  ds_read_b64_tr_b16 v[94:95], v2 offset:43520
  v_permlane32_swap_b32 v222, v220
  v_permlane32_swap_b32 v223, v221
  s_waitcnt lgkmcnt(8) vmcnt(7)
  v_mfma_f32_32x32x16_bf16 v[32:47], v[128:131], v[24:27], v[32:47]
  ds_read_b64_tr_b16 v[16:17], v2 offset:11264
  ds_read_b64_tr_b16 v[18:19], v2 offset:11776
  s_add_u32 s64, s64, 4096
  buffer_load_dwordx4 v[160:163], v1, s[24:27], s64 offen  sc1
  s_nop 1
  v_mfma_f32_32x32x16_bf16 v[48:63], v[128:131], v[28:31], v[48:63]
  ds_read_b64_tr_b16 v[20:21], v2 offset:44032
  ds_read_b64_tr_b16 v[22:23], v2 offset:44544
  v_add_f32 v222, v222, v220
  v_add_f32 v223, v223, v221
  s_waitcnt lgkmcnt(8) vmcnt(7)
  v_mfma_f32_32x32x16_bf16 v[32:47], v[132:135], v[80:83], v[32:47]
  ds_read_b64_tr_b16 v[24:25], v2 offset:12288
  ds_read_b64_tr_b16 v[26:27], v2 offset:12800
  buffer_load_dwordx4 v[164:167], v1, s[24:27], s64 offen offset:1024 sc1
  v_mul_f32 v222, 0x3b000000, v222
  v_mfma_f32_32x32x16_bf16 v[48:63], v[132:135], v[84:87], v[48:63]
  ds_read_b64_tr_b16 v[28:29], v2 offset:45056
  ds_read_b64_tr_b16 v[30:31], v2 offset:45568
  v_mul_f32 v223, 0x3b000000, v223
  v_fma_f32 v223, -v222, v222, v223
  s_waitcnt lgkmcnt(8) vmcnt(7)
  v_mfma_f32_32x32x16_bf16 v[32:47], v[136:139], v[88:91], v[32:47]
  ds_read_b64_tr_b16 v[80:81], v2 offset:13312
  ds_read_b64_tr_b16 v[82:83], v2 offset:13824
  buffer_load_dwordx4 v[168:171], v1, s[24:27], s64 offen offset:2048 sc1
  v_max_f32 v223, 0, v223
  v_mfma_f32_32x32x16_bf16 v[48:63], v[136:139], v[92:95], v[48:63]
  ds_read_b64_tr_b16 v[84:85], v2 offset:46080
  ds_read_b64_tr_b16 v[86:87], v2 offset:46592
  v_add_f32 v220, 0x3727c5ac, v223
  v_rsq_f32 v13, v220
  s_waitcnt lgkmcnt(8) vmcnt(7)
  v_mfma_f32_32x32x16_bf16 v[32:47], v[140:143], v[16:19], v[32:47]
  ds_read_b64_tr_b16 v[88:89], v2 offset:14336
  ds_read_b64_tr_b16 v[90:91], v2 offset:14848
  buffer_load_dwordx4 v[172:175], v1, s[24:27], s64 offen offset:3072 sc1
  v_mov_b32 v223, 0
  v_mfma_f32_32x32x16_bf16 v[48:63], v[140:143], v[20:23], v[48:63]
  ds_read_b64_tr_b16 v[92:93], v2 offset:47104
  ds_read_b64_tr_b16 v[94:95], v2 offset:47616
  v_cvt_pk_bf16_f32 v8, v222, v222
  v_cvt_pk_bf16_f32 v10, v223, v223
  s_waitcnt lgkmcnt(8) vmcnt(7)
  v_mfma_f32_32x32x16_bf16 v[32:47], v[144:147], v[24:27], v[32:47]
  ds_read_b64_tr_b16 v[16:17], v2 offset:15360
  ds_read_b64_tr_b16 v[18:19], v2 offset:15872
  s_add_u32 s64, s64, 4096
  buffer_load_dwordx4 v[176:179], v1, s[24:27], s64 offen  sc1
  v_and_b32 v220, 0xffff0000, v8
  v_mfma_f32_32x32x16_bf16 v[48:63], v[144:147], v[28:31], v[48:63]
  ds_read_b64_tr_b16 v[20:21], v2 offset:48128
  ds_read_b64_tr_b16 v[22:23], v2 offset:48640
  v_and_b32 v221, 0xffff0000, v10
  v_sub_f32 v220, v222, v220
  s_waitcnt lgkmcnt(8) vmcnt(7)
  v_mfma_f32_32x32x16_bf16 v[32:47], v[148:151], v[80:83], v[32:47]
  ds_read_b64_tr_b16 v[24:25], v2 offset:16384
  ds_read_b64_tr_b16 v[26:27], v2 offset:16896
  buffer_load_dwordx4 v[180:183], v1, s[24:27], s64 offen offset:1024 sc1
  v_sub_f32 v221, v223, v221
  v_mfma_f32_32x32x16_bf16 v[48:63], v[148:151], v[84:87], v[48:63]
  ds_read_b64_tr_b16 v[28:29], v2 offset:49152
  ds_read_b64_tr_b16 v[30:31], v2 offset:49664
  v_cvt_pk_bf16_f32 v9, v220, v223
  v_cvt_pk_bf16_f32 v10, v221, 0
  s_waitcnt lgkmcnt(8) vmcnt(7)
  v_mfma_f32_32x32x16_bf16 v[32:47], v[152:155], v[88:91], v[32:47]
  ds_read_b64_tr_b16 v[80:81], v2 offset:17408
  ds_read_b64_tr_b16 v[82:83], v2 offset:17920
  buffer_load_dwordx4 v[184:187], v1, s[24:27], s64 offen offset:2048 sc1
  v_mov_b32 v11, 0
  v_mfma_f32_32x32x16_bf16 v[48:63], v[152:155], v[92:95], v[48:63]
  ds_read_b64_tr_b16 v[84:85], v2 offset:50176
  ds_read_b64_tr_b16 v[86:87], v2 offset:50688
  s_lshl_b32 s60, s50, 7
  s_add_u32 s60, s60, 162816
  s_waitcnt lgkmcnt(8) vmcnt(7)
  v_mfma_f32_32x32x16_bf16 v[32:47], v[156:159], v[16:19], v[32:47]
  ds_read_b64_tr_b16 v[88:89], v2 offset:18432
  ds_read_b64_tr_b16 v[90:91], v2 offset:18944
  buffer_load_dwordx4 v[188:191], v1, s[24:27], s64 offen offset:3072 sc1
  v_and_b32 v12, 0x7c, v6
  v_mfma_f32_32x32x16_bf16 v[48:63], v[156:159], v[20:23], v[48:63]
  ds_read_b64_tr_b16 v[92:93], v2 offset:51200
  ds_read_b64_tr_b16 v[94:95], v2 offset:51712
  v_add_u32 v12, s60, v12
  ds_write_b32 v12, v13
  s_waitcnt lgkmcnt(8) vmcnt(7)
  v_mfma_f32_32x32x16_bf16 v[32:47], v[160:163], v[24:27], v[32:47]
  ds_read_b64_tr_b16 v[16:17], v2 offset:19456
  ds_read_b64_tr_b16 v[18:19], v2 offset:19968
  s_add_u32 s64, s64, 4096
  buffer_load_dwordx4 v[192:195], v1, s[24:27], s64 offen  sc1
  v_lshrrev_b32 v14, 5, v1
  v_mfma_f32_32x32x16_bf16 v[48:63], v[160:163], v[28:31], v[48:63]
  ds_read_b64_tr_b16 v[20:21], v2 offset:52224
  ds_read_b64_tr_b16 v[22:23], v2 offset:52736
  v_and_b32 v14, 16, v14
  v_add_u32 v14, s60, v14
  s_waitcnt lgkmcnt(8) vmcnt(7)
  v_mfma_f32_32x32x16_bf16 v[32:47], v[164:167], v[80:83], v[32:47]
  ds_read_b64_tr_b16 v[24:25], v2 offset:20480
  ds_read_b64_tr_b16 v[26:27], v2 offset:20992
  buffer_load_dwordx4 v[196:199], v1, s[24:27], s64 offen offset:1024 sc1
  v_mfma_f32_32x32x16_bf16 v[48:63], v[164:167], v[84:87], v[48:63]
  ds_read_b64_tr_b16 v[28:29], v2 offset:53248
  ds_read_b64_tr_b16 v[30:31], v2 offset:53760
  s_waitcnt lgkmcnt(8) vmcnt(7)
  v_mfma_f32_32x32x16_bf16 v[32:47], v[168:171], v[88:91], v[32:47]
  ds_read_b64_tr_b16 v[80:81], v2 offset:21504
  ds_read_b64_tr_b16 v[82:83], v2 offset:22016
  buffer_load_dwordx4 v[200:203], v1, s[24:27], s64 offen offset:2048 sc1
  v_mfma_f32_32x32x16_bf16 v[48:63], v[168:171], v[92:95], v[48:63]
  ds_read_b64_tr_b16 v[84:85], v2 offset:54272
  ds_read_b64_tr_b16 v[86:87], v2 offset:54784
  s_waitcnt lgkmcnt(8) vmcnt(7)
  v_mfma_f32_32x32x16_bf16 v[32:47], v[172:175], v[16:19], v[32:47]
  ds_read_b64_tr_b16 v[88:89], v2 offset:22528
  ds_read_b64_tr_b16 v[90:91], v2 offset:23040
  buffer_load_dwordx4 v[204:207], v1, s[24:27], s64 offen offset:3072 sc1
  v_mfma_f32_32x32x16_bf16 v[48:63], v[172:175], v[20:23], v[48:63]
  ds_read_b64_tr_b16 v[92:93], v2 offset:55296
  ds_read_b64_tr_b16 v[94:95], v2 offset:55808
  s_waitcnt lgkmcnt(8) vmcnt(7)
  v_mfma_f32_32x32x16_bf16 v[32:47], v[176:179], v[24:27], v[32:47]
  ds_read_b64_tr_b16 v[16:17], v2 offset:23552
  ds_read_b64_tr_b16 v[18:19], v2 offset:24064
  s_add_u32 s64, s64, 4096
  buffer_load_dwordx4 v[208:211], v1, s[24:27], s64 offen  sc1
  v_mfma_f32_32x32x16_bf16 v[48:63], v[176:179], v[28:31], v[48:63]
  ds_read_b64_tr_b16 v[20:21], v2 offset:56320
  ds_read_b64_tr_b16 v[22:23], v2 offset:56832
  s_waitcnt lgkmcnt(8) vmcnt(7)
  v_mfma_f32_32x32x16_bf16 v[32:47], v[180:183], v[80:83], v[32:47]
  ds_read_b64_tr_b16 v[24:25], v2 offset:24576
  ds_read_b64_tr_b16 v[26:27], v2 offset:25088
  buffer_load_dwordx4 v[212:215], v1, s[24:27], s64 offen offset:1024 sc1
  v_mfma_f32_32x32x16_bf16 v[48:63], v[180:183], v[84:87], v[48:63]
  ds_read_b64_tr_b16 v[28:29], v2 offset:57344
  ds_read_b64_tr_b16 v[30:31], v2 offset:57856
  s_waitcnt lgkmcnt(8) vmcnt(7)
  v_mfma_f32_32x32x16_bf16 v[32:47], v[184:187], v[88:91], v[32:47]
  ds_read_b64_tr_b16 v[80:81], v2 offset:25600
  ds_read_b64_tr_b16 v[82:83], v2 offset:26112
  buffer_load_dwordx4 v[216:219], v1, s[24:27], s64 offen offset:2048 sc1
  v_mfma_f32_32x32x16_bf16 v[48:63], v[184:187], v[92:95], v[48:63]
  ds_read_b64_tr_b16 v[84:85], v2 offset:58368
  ds_read_b64_tr_b16 v[86:87], v2 offset:58880
  s_waitcnt lgkmcnt(8) vmcnt(7)
  v_mfma_f32_32x32x16_bf16 v[32:47], v[188:191], v[16:19], v[32:47]
  ds_read_b64_tr_b16 v[88:89], v2 offset:26624
  ds_read_b64_tr_b16 v[90:91], v2 offset:27136
  buffer_load_dwordx4 v[220:223], v1, s[24:27], s64 offen offset:3072 sc1
  v_mfma_f32_32x32x16_bf16 v[48:63], v[188:191], v[20:23], v[48:63]
  ds_read_b64_tr_b16 v[92:93], v2 offset:59392
  ds_read_b64_tr_b16 v[94:95], v2 offset:59904
  s_waitcnt lgkmcnt(8) vmcnt(7)
  v_mfma_f32_32x32x16_bf16 v[32:47], v[192:195], v[24:27], v[32:47]
  ds_read_b64_tr_b16 v[16:17], v2 offset:27648
  ds_read_b64_tr_b16 v[18:19], v2 offset:28160
  v_lshlrev_b32 v12, 3, v1
  s_lshl_b32 s61, s51, 22
  s_add_u32 s61, s61, s81
  buffer_load_dword v15, v12, s[16:19], s61 offen
  v_mfma_f32_32x32x16_bf16 v[48:63], v[192:195], v[28:31], v[48:63]
  ds_read_b64_tr_b16 v[20:21], v2 offset:60416
  ds_read_b64_tr_b16 v[22:23], v2 offset:60928
  s_waitcnt lgkmcnt(8) vmcnt(7)
  v_mfma_f32_32x32x16_bf16 v[32:47], v[196:199], v[80:83], v[32:47]
  ds_read_b64_tr_b16 v[24:25], v2 offset:28672
  ds_read_b64_tr_b16 v[26:27], v2 offset:29184
  s_add_u32 s61, s61, 8192
  buffer_load_dword v15, v12, s[16:19], s61 offen
  v_mfma_f32_32x32x16_bf16 v[48:63], v[196:199], v[84:87], v[48:63]
  ds_read_b64_tr_b16 v[28:29], v2 offset:61440
  ds_read_b64_tr_b16 v[30:31], v2 offset:61952
  s_waitcnt lgkmcnt(8) vmcnt(7)
  v_mfma_f32_32x32x16_bf16 v[32:47], v[200:203], v[88:91], v[32:47]
  ds_read_b64_tr_b16 v[80:81], v2 offset:29696
  ds_read_b64_tr_b16 v[82:83], v2 offset:30208
  v_mfma_f32_32x32x16_bf16 v[48:63], v[200:203], v[92:95], v[48:63]
  ds_read_b64_tr_b16 v[84:85], v2 offset:62464
  ds_read_b64_tr_b16 v[86:87], v2 offset:62976
  s_waitcnt lgkmcnt(8) vmcnt(6)
  v_mfma_f32_32x32x16_bf16 v[32:47], v[204:207], v[16:19], v[32:47]
  ds_read_b64_tr_b16 v[88:89], v2 offset:30720
  ds_read_b64_tr_b16 v[90:91], v2 offset:31232
  v_mfma_f32_32x32x16_bf16 v[48:63], v[204:207], v[20:23], v[48:63]
  ds_read_b64_tr_b16 v[92:93], v2 offset:63488
  ds_read_b64_tr_b16 v[94:95], v2 offset:64000
  s_waitcnt lgkmcnt(8) vmcnt(5)
  v_mfma_f32_32x32x16_bf16 v[32:47], v[208:211], v[24:27], v[32:47]
  ds_read_b64_tr_b16 v[16:17], v2 offset:31744
  ds_read_b64_tr_b16 v[18:19], v2 offset:32256
  v_mfma_f32_32x32x16_bf16 v[48:63], v[208:211], v[28:31], v[48:63]
  ds_read_b64_tr_b16 v[20:21], v2 offset:64512
  ds_read_b64_tr_b16 v[22:23], v2 offset:65024
  s_waitcnt lgkmcnt(8) vmcnt(4)
  v_mfma_f32_32x32x16_bf16 v[32:47], v[212:215], v[80:83], v[32:47]
  ds_read_b128 v[24:27], v7 offset:0
  v_mfma_f32_32x32x16_bf16 v[48:63], v[212:215], v[84:87], v[48:63]
  ds_read_b128 v[28:31], v7 offset:1024
  s_waitcnt lgkmcnt(6) vmcnt(3)
  v_mfma_f32_32x32x16_bf16 v[32:47], v[216:219], v[88:91], v[32:47]
  ds_read_b128 v[80:83], v14 offset:0
  v_mfma_f32_32x32x16_bf16 v[48:63], v[216:219], v[92:95], v[48:63]
  ds_read_b128 v[84:87], v14 offset:32
  s_waitcnt lgkmcnt(4) vmcnt(2)
  v_mfma_f32_32x32x16_bf16 v[32:47], v[220:223], v[16:19], v[32:47]
  ds_read_b128 v[88:91], v14 offset:64
  v_mfma_f32_32x32x16_bf16 v[48:63], v[220:223], v[20:23], v[48:63]
  ds_read_b128 v[92:95], v14 offset:96
  s_waitcnt lgkmcnt(4)
  v_mfma_f32_32x32x16_bf16 v[32:47], v[8:11], v[24:27], v[32:47]
  v_mfma_f32_32x32x16_bf16 v[48:63], v[8:11], v[28:31], v[48:63]
  s_waitcnt lgkmcnt(0)
  s_nop 7
  s_nop 1
  v_fmaak_f32 v32, v32, v80, 0x358637bd
  v_fmaak_f32 v33, v33, v81, 0x358637bd
  v_fmaak_f32 v34, v34, v82, 0x358637bd
  v_fmaak_f32 v35, v35, v83, 0x358637bd
  v_mul_f32 v24, 0x3fb8aa3b, v32
  v_mul_f32 v25, 0x3fb8aa3b, v33
  v_mul_f32 v26, 0x3fb8aa3b, v34
  v_mul_f32 v27, 0x3fb8aa3b, v35
  v_exp_f32 v24, v24 clamp
  v_exp_f32 v25, v25 clamp
  v_exp_f32 v26, v26 clamp
  v_exp_f32 v27, v27 clamp
  v_max_f32 v32, 0x358637bd, v32
  v_max_f32 v33, 0x358637bd, v33
  v_max_f32 v34, 0x358637bd, v34
  v_max_f32 v35, 0x358637bd, v35
  v_pk_add_f32 v[32:33], v[32:33], v[24:25]
  v_pk_add_f32 v[34:35], v[34:35], v[26:27]
  v_cvt_pk_bf16_f32 v32, v32, v33
  v_cvt_pk_bf16_f32 v33, v34, v35
  v_fmaak_f32 v36, v36, v84, 0x358637bd
  v_fmaak_f32 v37, v37, v85, 0x358637bd
  v_fmaak_f32 v38, v38, v86, 0x358637bd
  v_fmaak_f32 v39, v39, v87, 0x358637bd
  v_mul_f32 v24, 0x3fb8aa3b, v36
  v_mul_f32 v25, 0x3fb8aa3b, v37
  v_mul_f32 v26, 0x3fb8aa3b, v38
  v_mul_f32 v27, 0x3fb8aa3b, v39
  v_exp_f32 v24, v24 clamp
  v_exp_f32 v25, v25 clamp
  v_exp_f32 v26, v26 clamp
  v_exp_f32 v27, v27 clamp
  v_max_f32 v36, 0x358637bd, v36
  v_max_f32 v37, 0x358637bd, v37
  v_max_f32 v38, 0x358637bd, v38
  v_max_f32 v39, 0x358637bd, v39
  v_pk_add_f32 v[36:37], v[36:37], v[24:25]
  v_pk_add_f32 v[38:39], v[38:39], v[26:27]
  v_cvt_pk_bf16_f32 v34, v36, v37
  v_cvt_pk_bf16_f32 v35, v38, v39
  v_fmaak_f32 v40, v40, v88, 0x358637bd
  v_fmaak_f32 v41, v41, v89, 0x358637bd
  v_fmaak_f32 v42, v42, v90, 0x358637bd
  v_fmaak_f32 v43, v43, v91, 0x358637bd
  v_mul_f32 v24, 0x3fb8aa3b, v40
  v_mul_f32 v25, 0x3fb8aa3b, v41
  v_mul_f32 v26, 0x3fb8aa3b, v42
  v_mul_f32 v27, 0x3fb8aa3b, v43
  v_exp_f32 v24, v24 clamp
  v_exp_f32 v25, v25 clamp
  v_exp_f32 v26, v26 clamp
  v_exp_f32 v27, v27 clamp
  v_max_f32 v40, 0x358637bd, v40
  v_max_f32 v41, 0x358637bd, v41
  v_max_f32 v42, 0x358637bd, v42
  v_max_f32 v43, 0x358637bd, v43
  v_pk_add_f32 v[40:41], v[40:41], v[24:25]
  v_pk_add_f32 v[42:43], v[42:43], v[26:27]
  v_cvt_pk_bf16_f32 v36, v40, v41
  v_cvt_pk_bf16_f32 v37, v42, v43
  v_fmaak_f32 v44, v44, v92, 0x358637bd
  v_fmaak_f32 v45, v45, v93, 0x358637bd
  v_fmaak_f32 v46, v46, v94, 0x358637bd
  v_fmaak_f32 v47, v47, v95, 0x358637bd
  v_mul_f32 v24, 0x3fb8aa3b, v44
  v_mul_f32 v25, 0x3fb8aa3b, v45
  v_mul_f32 v26, 0x3fb8aa3b, v46
  v_mul_f32 v27, 0x3fb8aa3b, v47
  v_exp_f32 v24, v24 clamp
  v_exp_f32 v25, v25 clamp
  v_exp_f32 v26, v26 clamp
  v_exp_f32 v27, v27 clamp
  v_max_f32 v44, 0x358637bd, v44
  v_max_f32 v45, 0x358637bd, v45
  v_max_f32 v46, 0x358637bd, v46
  v_max_f32 v47, 0x358637bd, v47
  v_pk_add_f32 v[44:45], v[44:45], v[24:25]
  v_pk_add_f32 v[46:47], v[46:47], v[26:27]
  v_cvt_pk_bf16_f32 v38, v44, v45
  v_cvt_pk_bf16_f32 v39, v46, v47
  v_pk_mul_f32 v[48:49], v[48:49], v[80:81]
  v_pk_mul_f32 v[50:51], v[50:51], v[82:83]
  v_pk_mul_f32 v[52:53], v[52:53], v[84:85]
  v_pk_mul_f32 v[54:55], v[54:55], v[86:87]
  v_pk_mul_f32 v[56:57], v[56:57], v[88:89]
  v_pk_mul_f32 v[58:59], v[58:59], v[90:91]
  v_pk_mul_f32 v[60:61], v[60:61], v[92:93]
  v_pk_mul_f32 v[62:63], v[62:63], v[94:95]
  v_cvt_pk_bf16_f32 v48, v48, v49
  v_cvt_pk_bf16_f32 v49, v50, v51
  v_cvt_pk_bf16_f32 v50, v52, v53
  v_cvt_pk_bf16_f32 v51, v54, v55
  v_cvt_pk_bf16_f32 v52, v56, v57
  v_cvt_pk_bf16_f32 v53, v58, v59
  v_cvt_pk_bf16_f32 v54, v60, v61
  v_cvt_pk_bf16_f32 v55, v62, v63
  v_mov_b32 v24, s93
  v_mov_b32 v25, s93
  v_mov_b32 v26, s93
  v_mov_b32 v27, s93
  v_mfma_f32_32x32x16_bf16 v[64:79], v[32:35], v[48:51], 0
  s_nop 0
  v_mfma_f32_32x32x16_bf16 v[80:95], v[32:35], v[24:27], 0
  v_mfma_f32_32x32x16_bf16 v[64:79], v[36:39], v[52:55], v[64:79]
  v_mfma_f32_32x32x16_bf16 v[80:95], v[36:39], v[24:27], v[80:95]
  s_lshl_b32 s60, s50, 12
  s_add_u32 s60, s60, 131072
  v_add_u32 v29, s60, v1
  s_lshl_b32 s60, s50, 10
  s_add_u32 s60, s60, 131072
  v_add_u32 v30, s60, v1
  v_and_b32 v28, 0x300, v1
  v_lshrrev_b32 v28, 4, v28
  v_add_u32 v28, 1024, v28
  s_cmp_lt_u32 s50, 2
  s_cselect_b64 vcc, -1, 0
  s_and_b32 s60, s50, 1
  s_lshl_b32 s60, s60, 3
  v_cndmask_b32 v28, v28, v1, vcc
  v_add_u32 v28, s60, v28
  v_cndmask_b32 v32, v72, v64, s[76:77]
  v_cndmask_b32 v33, v73, v65, s[76:77]
  v_cndmask_b32 v34, v74, v66, s[76:77]
  v_cndmask_b32 v35, v75, v67, s[76:77]
  v_cndmask_b32 v36, v76, v68, s[76:77]
  v_cndmask_b32 v37, v77, v69, s[76:77]
  v_cndmask_b32 v38, v78, v70, s[76:77]
  v_cndmask_b32 v39, v79, v71, s[76:77]
  v_cndmask_b32 v40, v80, v88, s[76:77]
  v_cndmask_b32 v41, v81, v89, s[76:77]
  v_cndmask_b32 v42, v82, v90, s[76:77]
  v_cndmask_b32 v43, v83, v91, s[76:77]
  v_cndmask_b32 v44, v84, v92, s[76:77]
  v_cndmask_b32 v45, v85, v93, s[76:77]
  v_cndmask_b32 v46, v86, v94, s[76:77]
  v_cndmask_b32 v47, v87, v95, s[76:77]
  ds_write_b128 v29, v[32:35] offset:0
  ds_write_b128 v29, v[36:39] offset:1024
  ds_write_b128 v29, v[40:43] offset:2048
  ds_write_b128 v29, v[44:47] offset:3072
  s_waitcnt lgkmcnt(0)
  s_barrier
  ds_read_b128 v[32:35], v30 offset:0
  ds_read_b128 v[36:39], v30 offset:4096
  ds_read_b128 v[40:43], v30 offset:8192
  ds_read_b128 v[44:47], v30 offset:12288
  s_mul_i32 s60, s48, 1152
  s_add_u32 s60, s60, s86
  s_waitcnt lgkmcnt(2)
  v_pk_add_f32 v[32:33], v[32:33], v[36:37]
  v_pk_add_f32 v[34:35], v[34:35], v[38:39]
  s_waitcnt lgkmcnt(0)
  v_pk_add_f32 v[40:41], v[40:41], v[44:45]
  v_pk_add_f32 v[42:43], v[42:43], v[46:47]
  v_pk_add_f32 v[32:33], v[32:33], v[40:41]
  v_pk_add_f32 v[34:35], v[34:35], v[42:43]
  v_cvt_pk_bf16_f32 v32, v32, v33
  v_cvt_pk_bf16_f32 v33, v34, v35
  buffer_store_dwordx2 v[32:33], v28, s[28:31], s60 offen sc1
  s_cmp_lg_u32 s51, 0
  s_cbranch_scc1 NHPW
  buffer_store_dwordx4 v[0:3], v1, s[24:27], s85 offen offset:0
  buffer_store_dwordx4 v[0:3], v1, s[24:27], s85 offen offset:1024
  buffer_store_dwordx4 v[0:3], v1, s[24:27], s85 offen offset:2048
  buffer_store_dwordx4 v[0:3], v1, s[24:27], s85 offen offset:3072
  buffer_store_dwordx4 v[0:3], v1, s[24:27], s80 offen offset:0
  buffer_store_dwordx4 v[0:3], v1, s[24:27], s80 offen offset:1024
  buffer_store_dwordx4 v[0:3], v1, s[24:27], s80 offen offset:2048
  buffer_store_dwordx4 v[0:3], v1, s[24:27], s80 offen offset:3072
NHPW:
  s_mul_i32 s62, s50, 16
  s_add_u32 s62, s62, 0
  s_mul_i32 s63, s62, 28672
  s_lshl_b32 s62, s62, 10
  s_add_u32 s62, s62, 0
  s_lshl_b32 s61, s49, 8
  s_add_u32 s63, s63, s61
  s_add_u32 s63, s63, 0
  s_mov_b32 m0, s62
  s_mov_b32 s60, s63
  ds_read_b64_tr_b16 v[80:81], v3 offset:0
  ds_read_b64_tr_b16 v[82:83], v3 offset:512
  ds_read_b64_tr_b16 v[84:85], v3 offset:1024
  ds_read_b64_tr_b16 v[86:87], v3 offset:1536
  ds_read_b64_tr_b16 v[88:89], v3 offset:2048
  ds_read_b64_tr_b16 v[90:91], v3 offset:2560
  ds_read_b64_tr_b16 v[92:93], v3 offset:3072
  ds_read_b64_tr_b16 v[94:95], v3 offset:3584
  s_waitcnt lgkmcnt(4)
  v_mfma_f32_32x32x16_bf16 v[64:79], v[80:83], v[96:99], 0
  ds_read_b64_tr_b16 v[40:41], v3 offset:4096
  ds_read_b64_tr_b16 v[42:43], v3 offset:4608
  buffer_load_dwordx4 v5, s[16:19], s60 offen  lds
  s_add_u32 m0, m0, 1024
  s_add_u32 s60, s60, 28672
  v_mfma_f32_32x32x16_bf16 v[64:79], v[84:87], v[100:103], v[64:79]
  ds_read_b64_tr_b16 v[44:45], v3 offset:5120
  ds_read_b64_tr_b16 v[46:47], v3 offset:5632
  s_waitcnt lgkmcnt(4)
  v_mfma_f32_32x32x16_bf16 v[64:79], v[88:91], v[104:107], v[64:79]
  ds_read_b64_tr_b16 v[80:81], v3 offset:6144
  ds_read_b64_tr_b16 v[82:83], v3 offset:6656
  buffer_load_dwordx4 v5, s[16:19], s60 offen  lds
  s_add_u32 m0, m0, 1024
  s_add_u32 s60, s60, 28672
  v_mfma_f32_32x32x16_bf16 v[64:79], v[92:95], v[108:111], v[64:79]
  ds_read_b64_tr_b16 v[84:85], v3 offset:7168
  ds_read_b64_tr_b16 v[86:87], v3 offset:7680
  s_waitcnt lgkmcnt(4)
  v_mfma_f32_32x32x16_bf16 v[64:79], v[40:43], v[112:115], v[64:79]
  ds_read_b64_tr_b16 v[88:89], v3 offset:8192
  ds_read_b64_tr_b16 v[90:91], v3 offset:8704
  buffer_load_dwordx4 v5, s[16:19], s60 offen  lds
  s_add_u32 m0, m0, 1024
  s_add_u32 s60, s60, 28672
  v_mfma_f32_32x32x16_bf16 v[64:79], v[44:47], v[116:119], v[64:79]
  ds_read_b64_tr_b16 v[92:93], v3 offset:9216
  ds_read_b64_tr_b16 v[94:95], v3 offset:9728
  s_waitcnt lgkmcnt(4)
  v_mfma_f32_32x32x16_bf16 v[64:79], v[80:83], v[120:123], v[64:79]
  ds_read_b64_tr_b16 v[40:41], v3 offset:10240
  ds_read_b64_tr_b16 v[42:43], v3 offset:10752
  buffer_load_dwordx4 v5, s[16:19], s60 offen  lds
  s_add_u32 m0, m0, 1024
  s_add_u32 s60, s60, 28672
  v_mfma_f32_32x32x16_bf16 v[64:79], v[84:87], v[124:127], v[64:79]
  ds_read_b64_tr_b16 v[44:45], v3 offset:11264
  ds_read_b64_tr_b16 v[46:47], v3 offset:11776
  s_waitcnt lgkmcnt(4)
  v_mfma_f32_32x32x16_bf16 v[64:79], v[88:91], v[128:131], v[64:79]
  ds_read_b64_tr_b16 v[80:81], v3 offset:12288
  ds_read_b64_tr_b16 v[82:83], v3 offset:12800
  buffer_load_dwordx4 v5, s[16:19], s60 offen  lds
  s_add_u32 m0, m0, 1024
  s_add_u32 s60, s60, 28672
  v_mfma_f32_32x32x16_bf16 v[64:79], v[92:95], v[132:135], v[64:79]
  ds_read_b64_tr_b16 v[84:85], v3 offset:13312
  ds_read_b64_tr_b16 v[86:87], v3 offset:13824
  s_waitcnt lgkmcnt(4)
  v_mfma_f32_32x32x16_bf16 v[64:79], v[40:43], v[136:139], v[64:79]
  ds_read_b64_tr_b16 v[88:89], v3 offset:14336
  ds_read_b64_tr_b16 v[90:91], v3 offset:14848
  buffer_load_dwordx4 v5, s[16:19], s60 offen  lds
  s_add_u32 m0, m0, 1024
  s_add_u32 s60, s60, 28672
  v_mfma_f32_32x32x16_bf16 v[64:79], v[44:47], v[140:143], v[64:79]
  ds_read_b64_tr_b16 v[92:93], v3 offset:15360
  ds_read_b64_tr_b16 v[94:95], v3 offset:15872
  s_waitcnt lgkmcnt(4)
  v_mfma_f32_32x32x16_bf16 v[64:79], v[80:83], v[144:147], v[64:79]
  ds_read_b64_tr_b16 v[40:41], v3 offset:16384
  ds_read_b64_tr_b16 v[42:43], v3 offset:16896
  buffer_load_dwordx4 v5, s[16:19], s60 offen  lds
  s_add_u32 m0, m0, 1024
  s_add_u32 s60, s60, 28672
  v_mfma_f32_32x32x16_bf16 v[64:79], v[84:87], v[148:151], v[64:79]
  ds_read_b64_tr_b16 v[44:45], v3 offset:17408
  ds_read_b64_tr_b16 v[46:47], v3 offset:17920
  s_waitcnt lgkmcnt(4)
  v_mfma_f32_32x32x16_bf16 v[64:79], v[88:91], v[152:155], v[64:79]
  ds_read_b64_tr_b16 v[80:81], v3 offset:18432
  ds_read_b64_tr_b16 v[82:83], v3 offset:18944
  buffer_load_dwordx4 v5, s[16:19], s60 offen  lds
  s_add_u32 m0, m0, 1024
  s_add_u32 s60, s60, 28672
  v_mfma_f32_32x32x16_bf16 v[64:79], v[92:95], v[156:159], v[64:79]
  ds_read_b64_tr_b16 v[84:85], v3 offset:19456
  ds_read_b64_tr_b16 v[86:87], v3 offset:19968
  s_waitcnt lgkmcnt(4)
  v_mfma_f32_32x32x16_bf16 v[64:79], v[40:43], v[160:163], v[64:79]
  ds_read_b64_tr_b16 v[88:89], v3 offset:20480
  ds_read_b64_tr_b16 v[90:91], v3 offset:20992
  buffer_load_dwordx4 v5, s[16:19], s60 offen  lds
  s_add_u32 m0, m0, 1024
  s_add_u32 s60, s60, 28672
  v_mfma_f32_32x32x16_bf16 v[64:79], v[44:47], v[164:167], v[64:79]
  ds_read_b64_tr_b16 v[92:93], v3 offset:21504
  ds_read_b64_tr_b16 v[94:95], v3 offset:22016
  s_waitcnt lgkmcnt(4)
  v_mfma_f32_32x32x16_bf16 v[64:79], v[80:83], v[168:171], v[64:79]
  ds_read_b64_tr_b16 v[40:41], v3 offset:22528
  ds_read_b64_tr_b16 v[42:43], v3 offset:23040
  buffer_load_dwordx4 v5, s[16:19], s60 offen  lds
  s_add_u32 m0, m0, 1024
  s_add_u32 s60, s60, 28672
  v_mfma_f32_32x32x16_bf16 v[64:79], v[84:87], v[172:175], v[64:79]
  ds_read_b64_tr_b16 v[44:45], v3 offset:23552
  ds_read_b64_tr_b16 v[46:47], v3 offset:24064
  s_waitcnt lgkmcnt(4)
  v_mfma_f32_32x32x16_bf16 v[64:79], v[88:91], v[176:179], v[64:79]
  ds_read_b64_tr_b16 v[80:81], v3 offset:24576
  ds_read_b64_tr_b16 v[82:83], v3 offset:25088
  buffer_load_dwordx4 v5, s[16:19], s60 offen  lds
  s_add_u32 m0, m0, 1024
  s_add_u32 s60, s60, 28672
  v_mfma_f32_32x32x16_bf16 v[64:79], v[92:95], v[180:183], v[64:79]
  ds_read_b64_tr_b16 v[84:85], v3 offset:25600
  ds_read_b64_tr_b16 v[86:87], v3 offset:26112
  s_waitcnt lgkmcnt(4)
  v_mfma_f32_32x32x16_bf16 v[64:79], v[40:43], v[184:187], v[64:79]
  ds_read_b64_tr_b16 v[88:89], v3 offset:26624
  ds_read_b64_tr_b16 v[90:91], v3 offset:27136
  buffer_load_dwordx4 v5, s[16:19], s60 offen  lds
  s_add_u32 m0, m0, 1024
  s_add_u32 s60, s60, 28672
  v_mfma_f32_32x32x16_bf16 v[64:79], v[44:47], v[188:191], v[64:79]
  ds_read_b64_tr_b16 v[92:93], v3 offset:27648
  ds_read_b64_tr_b16 v[94:95], v3 offset:28160
  s_waitcnt lgkmcnt(4)
  v_mfma_f32_32x32x16_bf16 v[64:79], v[80:83], v[192:195], v[64:79]
  ds_read_b64_tr_b16 v[40:41], v3 offset:28672
  ds_read_b64_tr_b16 v[42:43], v3 offset:29184
  buffer_load_dwordx4 v5, s[16:19], s60 offen  lds
  s_add_u32 m0, m0, 1024
  s_add_u32 s60, s60, 28672
  v_mfma_f32_32x32x16_bf16 v[64:79], v[84:87], v[196:199], v[64:79]
  ds_read_b64_tr_b16 v[44:45], v3 offset:29696
  ds_read_b64_tr_b16 v[46:47], v3 offset:30208
  s_waitcnt lgkmcnt(4)
  v_mfma_f32_32x32x16_bf16 v[64:79], v[88:91], v[200:203], v[64:79]
  ds_read_b64_tr_b16 v[80:81], v3 offset:30720
  ds_read_b64_tr_b16 v[82:83], v3 offset:31232
  buffer_load_dwordx4 v5, s[16:19], s60 offen  lds
  s_add_u32 m0, m0, 1024
  s_add_u32 s60, s60, 28672
  v_mfma_f32_32x32x16_bf16 v[64:79], v[92:95], v[204:207], v[64:79]
  ds_read_b64_tr_b16 v[84:85], v3 offset:31744
  ds_read_b64_tr_b16 v[86:87], v3 offset:32256
  s_waitcnt lgkmcnt(4)
  v_mfma_f32_32x32x16_bf16 v[64:79], v[40:43], v[208:211], v[64:79]
  ds_read_b128 v[88:91], v7 offset:2048
  buffer_load_dwordx4 v5, s[16:19], s60 offen  lds
  s_add_u32 m0, m0, 1024
  s_add_u32 s60, s60, 28672
  v_mfma_f32_32x32x16_bf16 v[64:79], v[44:47], v[212:215], v[64:79]
  s_waitcnt lgkmcnt(1)
  v_mfma_f32_32x32x16_bf16 v[64:79], v[80:83], v[216:219], v[64:79]
  buffer_load_dwordx4 v5, s[16:19], s60 offen  lds
  s_add_u32 m0, m0, 1024
  s_add_u32 s60, s60, 28672
  v_mfma_f32_32x32x16_bf16 v[64:79], v[84:87], v[220:223], v[64:79]
  s_waitcnt lgkmcnt(0)
  v_mfma_f32_32x32x16_bf16 v[64:79], v[88:91], v[8:11], v[64:79]
  s_mul_i32 s66, s50, 4608
  s_add_u32 s66, s66, s86
  s_add_u32 s67, s66, 2304
  v_and_b32 v31, 0x300, v1
  v_lshrrev_b32 v31, 4, v31
  s_mov_b32 s61, 200000
  buffer_load_dwordx4 v[96:99], v1, s[28:31], s66 offen offset:0 sc1
  buffer_load_dwordx4 v[100:103], v31, s[28:31], s66 offen offset:1024 sc1
  buffer_load_dwordx4 v[104:107], v1, s[28:31], s66 offen offset:1152 sc1
  buffer_load_dwordx4 v[108:111], v31, s[28:31], s66 offen offset:2176 sc1
  buffer_load_dwordx4 v[112:115], v1, s[28:31], s67 offen offset:0 sc1
  buffer_load_dwordx4 v[116:119], v31, s[28:31], s67 offen offset:1024 sc1
  buffer_load_dwordx4 v[120:123], v1, s[28:31], s67 offen offset:1152 sc1
  buffer_load_dwordx4 v[124:127], v31, s[28:31], s67 offen offset:2176 sc1
  v_fmaak_f32 v64, v64, v13, 0x358637bd
  v_fmaak_f32 v65, v65, v13, 0x358637bd
  v_fmaak_f32 v66, v66, v13, 0x358637bd
  v_fmaak_f32 v67, v67, v13, 0x358637bd
  v_mul_f32 v24, 0x3fb8aa3b, v64
  v_mul_f32 v25, 0x3fb8aa3b, v65
  v_mul_f32 v26, 0x3fb8aa3b, v66
  v_mul_f32 v27, 0x3fb8aa3b, v67
  v_exp_f32 v24, v24 clamp
  v_exp_f32 v25, v25 clamp
  v_exp_f32 v26, v26 clamp
  v_exp_f32 v27, v27 clamp
  v_max_f32 v64, 0x358637bd, v64
  v_max_f32 v65, 0x358637bd, v65
  v_max_f32 v66, 0x358637bd, v66
  v_max_f32 v67, 0x358637bd, v67
  v_pk_add_f32 v[64:65], v[64:65], v[24:25]
  v_pk_add_f32 v[66:67], v[66:67], v[26:27]
  v_cvt_pk_bf16_f32 v64, v64, v65
  v_cvt_pk_bf16_f32 v65, v66, v67
  v_fmaak_f32 v68, v68, v13, 0x358637bd
  v_fmaak_f32 v69, v69, v13, 0x358637bd
  v_fmaak_f32 v70, v70, v13, 0x358637bd
  v_fmaak_f32 v71, v71, v13, 0x358637bd
  v_mul_f32 v24, 0x3fb8aa3b, v68
  v_mul_f32 v25, 0x3fb8aa3b, v69
  v_mul_f32 v26, 0x3fb8aa3b, v70
  v_mul_f32 v27, 0x3fb8aa3b, v71
  v_exp_f32 v24, v24 clamp
  v_exp_f32 v25, v25 clamp
  v_exp_f32 v26, v26 clamp
  v_exp_f32 v27, v27 clamp
  v_max_f32 v68, 0x358637bd, v68
  v_max_f32 v69, 0x358637bd, v69
  v_max_f32 v70, 0x358637bd, v70
  v_max_f32 v71, 0x358637bd, v71
  v_pk_add_f32 v[68:69], v[68:69], v[24:25]
  v_pk_add_f32 v[70:71], v[70:71], v[26:27]
  v_cvt_pk_bf16_f32 v66, v68, v69
  v_cvt_pk_bf16_f32 v67, v70, v71
  v_fmaak_f32 v72, v72, v13, 0x358637bd
  v_fmaak_f32 v73, v73, v13, 0x358637bd
  v_fmaak_f32 v74, v74, v13, 0x358637bd
  v_fmaak_f32 v75, v75, v13, 0x358637bd
  v_mul_f32 v24, 0x3fb8aa3b, v72
  v_mul_f32 v25, 0x3fb8aa3b, v73
  v_mul_f32 v26, 0x3fb8aa3b, v74
  v_mul_f32 v27, 0x3fb8aa3b, v75
  v_exp_f32 v24, v24 clamp
  v_exp_f32 v25, v25 clamp
  v_exp_f32 v26, v26 clamp
  v_exp_f32 v27, v27 clamp
  v_max_f32 v72, 0x358637bd, v72
  v_max_f32 v73, 0x358637bd, v73
  v_max_f32 v74, 0x358637bd, v74
  v_max_f32 v75, 0x358637bd, v75
  v_pk_add_f32 v[72:73], v[72:73], v[24:25]
  v_pk_add_f32 v[74:75], v[74:75], v[26:27]
  v_cvt_pk_bf16_f32 v68, v72, v73
  v_cvt_pk_bf16_f32 v69, v74, v75
  v_fmaak_f32 v76, v76, v13, 0x358637bd
  v_fmaak_f32 v77, v77, v13, 0x358637bd
  v_fmaak_f32 v78, v78, v13, 0x358637bd
  v_fmaak_f32 v79, v79, v13, 0x358637bd
  v_mul_f32 v24, 0x3fb8aa3b, v76
  v_mul_f32 v25, 0x3fb8aa3b, v77
  v_mul_f32 v26, 0x3fb8aa3b, v78
  v_mul_f32 v27, 0x3fb8aa3b, v79
  v_exp_f32 v24, v24 clamp
  v_exp_f32 v25, v25 clamp
  v_exp_f32 v26, v26 clamp
  v_exp_f32 v27, v27 clamp
  v_max_f32 v76, 0x358637bd, v76
  v_max_f32 v77, 0x358637bd, v77
  v_max_f32 v78, 0x358637bd, v78
  v_max_f32 v79, 0x358637bd, v79
  v_pk_add_f32 v[76:77], v[76:77], v[24:25]
  v_pk_add_f32 v[78:79], v[78:79], v[26:27]
  v_cvt_pk_bf16_f32 v70, v76, v77
  v_cvt_pk_bf16_f32 v71, v78, v79
  s_waitcnt vmcnt(0)
  s_branch KVC
KVP:
  buffer_load_dwordx4 v[96:99], v1, s[28:31], s66 offen offset:0 sc1
  buffer_load_dwordx4 v[100:103], v31, s[28:31], s66 offen offset:1024 sc1
  buffer_load_dwordx4 v[104:107], v1, s[28:31], s66 offen offset:1152 sc1
  buffer_load_dwordx4 v[108:111], v31, s[28:31], s66 offen offset:2176 sc1
  buffer_load_dwordx4 v[112:115], v1, s[28:31], s67 offen offset:0 sc1
  buffer_load_dwordx4 v[116:119], v31, s[28:31], s67 offen offset:1024 sc1
  buffer_load_dwordx4 v[120:123], v1, s[28:31], s67 offen offset:1152 sc1
  buffer_load_dwordx4 v[124:127], v31, s[28:31], s67 offen offset:2176 sc1
  s_sub_u32 s61, s61, 1
  s_cbranch_scc1 FIN
  s_waitcnt vmcnt(0)
KVC:
  v_max_u32 v24, v96, v97
  v_max_u32 v25, v98, v99
  v_max3_u32 v24, v24, v100, v101
  v_max3_u32 v25, v25, v102, v103
  v_max3_u32 v24, v24, v104, v105
  v_max3_u32 v25, v25, v106, v107
  v_max3_u32 v24, v24, v108, v109
  v_max3_u32 v25, v25, v110, v111
  v_max3_u32 v24, v24, v112, v113
  v_max3_u32 v25, v25, v114, v115
  v_max3_u32 v24, v24, v116, v117
  v_max3_u32 v25, v25, v118, v119
  v_max3_u32 v24, v24, v120, v121
  v_max3_u32 v25, v25, v122, v123
  v_max3_u32 v24, v24, v124, v125
  v_max3_u32 v25, v25, v126, v127
  v_max_u32 v24, v24, v25
  v_cmp_eq_u32 vcc, -1, v24
  s_cmp_eq_u64 vcc, 0
  s_cbranch_scc0 KVP
  v_lshlrev_b32 v32, 16, v96
  v_and_b32 v33, 0xffff0000, v96
  v_lshlrev_b32 v34, 16, v97
  v_and_b32 v35, 0xffff0000, v97
  v_lshlrev_b32 v36, 16, v98
  v_and_b32 v37, 0xffff0000, v98
  v_lshlrev_b32 v38, 16, v99
  v_and_b32 v39, 0xffff0000, v99
  v_lshlrev_b32 v40, 16, v100
  v_and_b32 v41, 0xffff0000, v100
  v_lshlrev_b32 v42, 16, v101
  v_and_b32 v43, 0xffff0000, v101
  v_lshlrev_b32 v44, 16, v102
  v_and_b32 v45, 0xffff0000, v102
  v_lshlrev_b32 v46, 16, v103
  v_and_b32 v47, 0xffff0000, v103
  v_dot2c_f32_bf16 v32, s91, v104
  v_dot2c_f32_bf16 v33, s92, v104
  v_dot2c_f32_bf16 v34, s91, v105
  v_dot2c_f32_bf16 v35, s92, v105
  v_dot2c_f32_bf16 v36, s91, v106
  v_dot2c_f32_bf16 v37, s92, v106
  v_dot2c_f32_bf16 v38, s91, v107
  v_dot2c_f32_bf16 v39, s92, v107
  v_dot2c_f32_bf16 v40, s91, v108
  v_dot2c_f32_bf16 v41, s92, v108
  v_dot2c_f32_bf16 v42, s91, v109
  v_dot2c_f32_bf16 v43, s92, v109
  v_dot2c_f32_bf16 v44, s91, v110
  v_dot2c_f32_bf16 v45, s92, v110
  v_dot2c_f32_bf16 v46, s91, v111
  v_dot2c_f32_bf16 v47, s92, v111
  v_dot2c_f32_bf16 v32, s91, v112
  v_dot2c_f32_bf16 v33, s92, v112
  v_dot2c_f32_bf16 v34, s91, v113
  v_dot2c_f32_bf16 v35, s92, v113
  v_dot2c_f32_bf16 v36, s91, v114
  v_dot2c_f32_bf16 v37, s92, v114
  v_dot2c_f32_bf16 v38, s91, v115
  v_dot2c_f32_bf16 v39, s92, v115
  v_dot2c_f32_bf16 v40, s91, v116
  v_dot2c_f32_bf16 v41, s92, v116
  v_dot2c_f32_bf16 v42, s91, v117
  v_dot2c_f32_bf16 v43, s92, v117
  v_dot2c_f32_bf16 v44, s91, v118
  v_dot2c_f32_bf16 v45, s92, v118
  v_dot2c_f32_bf16 v46, s91, v119
  v_dot2c_f32_bf16 v47, s92, v119
  v_dot2c_f32_bf16 v32, s91, v120
  v_dot2c_f32_bf16 v33, s92, v120
  v_dot2c_f32_bf16 v34, s91, v121
  v_dot2c_f32_bf16 v35, s92, v121
  v_dot2c_f32_bf16 v36, s91, v122
  v_dot2c_f32_bf16 v37, s92, v122
  v_dot2c_f32_bf16 v38, s91, v123
  v_dot2c_f32_bf16 v39, s92, v123
  v_dot2c_f32_bf16 v40, s91, v124
  v_dot2c_f32_bf16 v41, s92, v124
  v_dot2c_f32_bf16 v42, s91, v125
  v_dot2c_f32_bf16 v43, s92, v125
  v_dot2c_f32_bf16 v44, s91, v126
  v_dot2c_f32_bf16 v45, s92, v126
  v_dot2c_f32_bf16 v46, s91, v127
  v_dot2c_f32_bf16 v47, s92, v127
  s_lshl_b32 s60, s50, 11
  v_add_u32 v30, 114688, v1
  v_add_u32 v29, s60, v30
  v_cvt_pk_bf16_f32 v32, v32, v33
  v_cvt_pk_bf16_f32 v33, v34, v35
  v_cvt_pk_bf16_f32 v34, v36, v37
  v_cvt_pk_bf16_f32 v35, v38, v39
  v_cvt_pk_bf16_f32 v36, v40, v41
  v_cvt_pk_bf16_f32 v37, v42, v43
  v_cvt_pk_bf16_f32 v38, v44, v45
  v_cvt_pk_bf16_f32 v39, v46, v47
  v_cndmask_b32 v40, v36, v32, s[76:77]
  v_cndmask_b32 v41, v37, v33, s[76:77]
  v_cndmask_b32 v42, v38, v34, s[76:77]
  v_cndmask_b32 v43, v39, v35, s[76:77]
  ds_write_b128 v29, v[40:43]
  v_cndmask_b32 v44, v32, v36, s[76:77]
  v_cndmask_b32 v45, v33, v37, s[76:77]
  v_cndmask_b32 v46, v34, v38, s[76:77]
  v_cndmask_b32 v47, v35, v39, s[76:77]
  ds_write_b128 v29, v[44:47] offset:1024
  s_waitcnt lgkmcnt(0)
  s_barrier
  ds_read_b128 v[96:99], v30 offset:0
  ds_read_b128 v[100:103], v30 offset:2048
  ds_read_b128 v[104:107], v30 offset:4096
  ds_read_b128 v[108:111], v30 offset:6144
  ds_read_b128 v[112:115], v30 offset:1024
  ds_read_b128 v[116:119], v30 offset:3072
  ds_read_b128 v[120:123], v30 offset:5120
  ds_read_b128 v[124:127], v30 offset:7168
  s_waitcnt lgkmcnt(7)
  v_mfma_f32_32x32x16_bf16 v[32:47], v[96:99], v[64:67], 0
  s_waitcnt lgkmcnt(6)
  v_mfma_f32_32x32x16_bf16 v[32:47], v[100:103], v[64:67], v[32:47]
  s_waitcnt lgkmcnt(5)
  v_mfma_f32_32x32x16_bf16 v[32:47], v[104:107], v[64:67], v[32:47]
  s_waitcnt lgkmcnt(4)
  v_mfma_f32_32x32x16_bf16 v[32:47], v[108:111], v[64:67], v[32:47]
  s_waitcnt lgkmcnt(3)
  v_mfma_f32_32x32x16_bf16 v[48:63], v[112:115], v[68:71], 0
  s_waitcnt lgkmcnt(2)
  v_mfma_f32_32x32x16_bf16 v[48:63], v[116:119], v[68:71], v[48:63]
  s_waitcnt lgkmcnt(1)
  v_mfma_f32_32x32x16_bf16 v[48:63], v[120:123], v[68:71], v[48:63]
  s_nop 5
  v_add_f32 v24, 0x358637bd, v40
  v_rcp_f32 v24, v24
  s_nop 0
  v_mul_f32 v32, v32, v24
  v_mul_f32 v33, v33, v24
  v_mul_f32 v34, v34, v24
  s_waitcnt lgkmcnt(0)
  v_mfma_f32_32x32x16_bf16 v[48:63], v[124:127], v[68:71], v[48:63]
  v_mul_f32 v35, v35, v24
  v_mul_f32 v36, v36, v24
  v_mul_f32 v37, v37, v24
  v_mul_f32 v38, v38, v24
  v_mul_f32 v39, v39, v24
  v_cvt_pk_bf16_f32 v32, v32, v33
  v_cvt_pk_bf16_f32 v33, v34, v35
  v_cvt_pk_bf16_f32 v34, v36, v37
  v_cvt_pk_bf16_f32 v35, v38, v39
  buffer_store_dwordx4 v[32:35], v1, s[24:27], s84 offen offset:0
  s_nop 1
  v_add_f32 v26, 0x358637bd, v48
  v_rcp_f32 v26, v26
  s_nop 0
  v_pk_mul_f32 v[56:57], v[56:57], v[26:27] op_sel_hi:[1,0]
  v_pk_mul_f32 v[58:59], v[58:59], v[26:27] op_sel_hi:[1,0]
  v_pk_mul_f32 v[60:61], v[60:61], v[26:27] op_sel_hi:[1,0]
  v_pk_mul_f32 v[62:63], v[62:63], v[26:27] op_sel_hi:[1,0]
  v_cvt_pk_bf16_f32 v56, v56, v57
  v_cvt_pk_bf16_f32 v57, v58, v59
  v_cvt_pk_bf16_f32 v58, v60, v61
  v_cvt_pk_bf16_f32 v59, v62, v63
  buffer_store_dwordx4 v[56:59], v1, s[24:27], s84 offen offset:1024
  s_add_u32 s60, s83, 0
  s_cmp_lg_u32 s52, 0
  s_waitcnt vmcnt(0)
  s_mov_b64 exec, 1
  s_cbranch_scc1 SL8
  buffer_store_dword v3, off, s[24:27], s60
DN9:
  s_mov_b64 exec, -1
  s_barrier
  buffer_load_dwordx4 v[16:19], v1, s[24:27], s96 offen sc1
  buffer_load_dwordx4 v[20:23], v1, s[24:27], s96 offen offset:1024 sc1
  s_add_u32 s60, s82, 0
  s_mov_b32 s61, 200000
  s_cmp_ge_u32 s49, 14
  s_cselect_b32 s62, 1, s51
  s_cmp_lg_u32 s62, 0
  s_cbranch_scc1 L10
  s_and_b32 s66, s50, 1
  s_lshr_b32 s62, s50, 1
  s_lshl_b32 s64, s49, 8
  s_lshl_b32 s63, s66, 6
  s_add_u32 s64, s64, s63
  v_bfe_u32 v25, v6, 1, 6
  buffer_load_ushort v26, v25, s[40:43], s64 offen offset:0
  s_mul_i32 s64, s62, 32768
  s_lshl_b32 s63, s66, 9
  s_add_u32 s64, s64, s63
  v_add_u32 v25, s64, v2
  s_lshl_b32 s67, s66, 10
  s_add_u32 s67, s67, 3072
  s_lshl_b32 s62, s62, 5
  s_lshl_b64 s[64:65], s[78:79], s62
  v_mov_b32 v28, 0
  v_mov_b32 v29, 0
  v_mov_b32 v30, 0
  v_mov_b32 v31, 0
  v_add_u32 v27, s67, v7
  ds_read_b64_tr_b16 v[32:33], v25 offset:0
  ds_read_b64_tr_b16 v[34:35], v25 offset:1024
  ds_read_b64_tr_b16 v[36:37], v25 offset:2048
  ds_read_b64_tr_b16 v[38:39], v25 offset:3072
  ds_read_b64_tr_b16 v[40:41], v25 offset:4096
  ds_read_b64_tr_b16 v[42:43], v25 offset:5120
  ds_read_b64_tr_b16 v[44:45], v25 offset:6144
  ds_read_b64_tr_b16 v[46:47], v25 offset:7168
  ds_read_b64_tr_b16 v[48:49], v25 offset:8192
  ds_read_b64_tr_b16 v[50:51], v25 offset:9216
  ds_read_b64_tr_b16 v[52:53], v25 offset:10240
  ds_read_b64_tr_b16 v[54:55], v25 offset:11264
  ds_read_b64_tr_b16 v[56:57], v25 offset:12288
  ds_read_b64_tr_b16 v[58:59], v25 offset:13312
  s_waitcnt lgkmcnt(12)
  v_dot2c_f32_bf16 v28, s93, v32
  v_dot2c_f32_bf16 v29, s93, v33
  v_dot2c_f32_bf16 v30, s93, v34
  v_dot2c_f32_bf16 v31, s93, v35
  ds_read_b64_tr_b16 v[60:61], v25 offset:14336
  ds_read_b64_tr_b16 v[62:63], v25 offset:15360
  s_waitcnt lgkmcnt(12)
  v_dot2c_f32_bf16 v28, s93, v36
  v_dot2c_f32_bf16 v29, s93, v37
  v_dot2c_f32_bf16 v30, s93, v38
  v_dot2c_f32_bf16 v31, s93, v39
  ds_read_b64_tr_b16 v[32:33], v25 offset:16384
  ds_read_b64_tr_b16 v[34:35], v25 offset:17408
  s_waitcnt lgkmcnt(12)
  v_dot2c_f32_bf16 v28, s93, v40
  v_dot2c_f32_bf16 v29, s93, v41
  v_dot2c_f32_bf16 v30, s93, v42
  v_dot2c_f32_bf16 v31, s93, v43
  ds_read_b64_tr_b16 v[36:37], v25 offset:18432
  ds_read_b64_tr_b16 v[38:39], v25 offset:19456
  s_waitcnt lgkmcnt(12)
  v_dot2c_f32_bf16 v28, s93, v44
  v_dot2c_f32_bf16 v29, s93, v45
  v_dot2c_f32_bf16 v30, s93, v46
  v_dot2c_f32_bf16 v31, s93, v47
  ds_read_b64_tr_b16 v[40:41], v25 offset:20480
  ds_read_b64_tr_b16 v[42:43], v25 offset:21504
  s_waitcnt lgkmcnt(12)
  v_dot2c_f32_bf16 v28, s93, v48
  v_dot2c_f32_bf16 v29, s93, v49
  v_dot2c_f32_bf16 v30, s93, v50
  v_dot2c_f32_bf16 v31, s93, v51
  ds_read_b64_tr_b16 v[44:45], v25 offset:22528
  ds_read_b64_tr_b16 v[46:47], v25 offset:23552
  s_waitcnt lgkmcnt(12)
  v_dot2c_f32_bf16 v28, s93, v52
  v_dot2c_f32_bf16 v29, s93, v53
  v_dot2c_f32_bf16 v30, s93, v54
  v_dot2c_f32_bf16 v31, s93, v55
  ds_read_b64_tr_b16 v[48:49], v25 offset:24576
  ds_read_b64_tr_b16 v[50:51], v25 offset:25600
  s_waitcnt lgkmcnt(12)
  v_dot2c_f32_bf16 v28, s93, v56
  v_dot2c_f32_bf16 v29, s93, v57
  v_dot2c_f32_bf16 v30, s93, v58
  v_dot2c_f32_bf16 v31, s93, v59
  ds_read_b64_tr_b16 v[52:53], v25 offset:26624
  ds_read_b64_tr_b16 v[54:55], v25 offset:27648
  s_waitcnt lgkmcnt(12)
  v_dot2c_f32_bf16 v28, s93, v60
  v_dot2c_f32_bf16 v29, s93, v61
  v_dot2c_f32_bf16 v30, s93, v62
  v_dot2c_f32_bf16 v31, s93, v63
  ds_read_b64_tr_b16 v[56:57], v25 offset:28672
  ds_read_b64_tr_b16 v[58:59], v25 offset:29696
  buffer_load_dword v24, v6, s[24:27], s60 offen sc1
  s_waitcnt lgkmcnt(12)
  v_dot2c_f32_bf16 v28, s93, v32
  v_dot2c_f32_bf16 v29, s93, v33
  v_dot2c_f32_bf16 v30, s93, v34
  v_dot2c_f32_bf16 v31, s93, v35
  ds_read_b64_tr_b16 v[60:61], v25 offset:30720
  ds_read_b64_tr_b16 v[62:63], v25 offset:31744
  s_waitcnt lgkmcnt(12)
  v_dot2c_f32_bf16 v28, s93, v36
  v_dot2c_f32_bf16 v29, s93, v37
  v_dot2c_f32_bf16 v30, s93, v38
  v_dot2c_f32_bf16 v31, s93, v39
  s_waitcnt lgkmcnt(10)
  v_dot2c_f32_bf16 v28, s93, v40
  v_dot2c_f32_bf16 v29, s93, v41
  v_dot2c_f32_bf16 v30, s93, v42
  v_dot2c_f32_bf16 v31, s93, v43
  s_waitcnt lgkmcnt(8)
  v_dot2c_f32_bf16 v28, s93, v44
  v_dot2c_f32_bf16 v29, s93, v45
  v_dot2c_f32_bf16 v30, s93, v46
  v_dot2c_f32_bf16 v31, s93, v47
  s_waitcnt lgkmcnt(6)
  v_dot2c_f32_bf16 v28, s93, v48
  v_dot2c_f32_bf16 v29, s93, v49
  v_dot2c_f32_bf16 v30, s93, v50
  v_dot2c_f32_bf16 v31, s93, v51
  s_waitcnt lgkmcnt(4)
  v_dot2c_f32_bf16 v28, s93, v52
  v_dot2c_f32_bf16 v29, s93, v53
  v_dot2c_f32_bf16 v30, s93, v54
  v_dot2c_f32_bf16 v31, s93, v55
  s_waitcnt lgkmcnt(2)
  v_dot2c_f32_bf16 v28, s93, v56
  v_dot2c_f32_bf16 v29, s93, v57
  v_dot2c_f32_bf16 v30, s93, v58
  v_dot2c_f32_bf16 v31, s93, v59
  s_waitcnt lgkmcnt(0)
  v_dot2c_f32_bf16 v28, s93, v60
  v_dot2c_f32_bf16 v29, s93, v61
  v_dot2c_f32_bf16 v30, s93, v62
  v_dot2c_f32_bf16 v31, s93, v63
  s_nop 2
  v_pk_add_f32 v[28:29], v[28:29], v[30:31]
  v_add_f32 v32, v28, v29
  v_mov_b32 v33, v32
  s_nop 1
  v_permlane32_swap_b32 v32, v33
  s_nop 1
  v_add_f32 v32, v32, v33
  v_cvt_pk_bf16_f32 v28, v32, v32
  v_and_b32 v28, 0xffff0000, v28
  v_sub_f32 v28, v32, v28
  v_cvt_pk_bf16_f32 v28, -v32, -v28
  v_and_b32 v29, 0xffff, v28
  v_mov_b32 v31, 0
  s_waitcnt vmcnt(1)
  v_lshl_or_b32 v29, v26, 16, v29
  v_mov_b32 v30, v26
  s_mov_b64 exec, s[64:65]
  ds_write_b128 v27, v[28:31]
  s_mov_b64 exec, -1
  s_waitcnt lgkmcnt(0)
  s_branch DN11
L10:
  buffer_load_dword v24, v6, s[24:27], s60 offen sc1
DN11:
  s_sub_u32 s61, s61, 1
  s_cbranch_scc1 FIN
  s_waitcnt vmcnt(0)
  v_cmp_ne_u32 vcc, 0, v24
  s_and_b64 s[62:63], vcc, s[72:73]
  s_cmp_eq_u64 s[62:63], s[72:73]
  s_cbranch_scc0 L10
  s_cmp_lg_u32 s52, 0
  s_cbranch_scc1 SL12
DN13:
  s_lshl_b32 s66, s50, 13
  s_add_u32 s66, s66, 131072
  s_mul_i32 s64, s90, 32768
  s_add_u32 s64, s64, s66
  s_mul_i32 s65, s89, 32768
  s_add_u32 s65, s65, s66
  buffer_load_dwordx4 v[96:99], v1, s[24:27], s64 offen  sc1
  buffer_load_dwordx4 v[100:103], v1, s[24:27], s64 offen offset:1024 sc1
  buffer_load_dwordx4 v[104:107], v1, s[24:27], s64 offen offset:2048 sc1
  buffer_load_dwordx4 v[108:111], v1, s[24:27], s64 offen offset:3072 sc1
  s_add_u32 s64, s64, 4096
  buffer_load_dwordx4 v[112:115], v1, s[24:27], s64 offen  sc1
  buffer_load_dwordx4 v[116:119], v1, s[24:27], s64 offen offset:1024 sc1
  buffer_load_dwordx4 v[120:123], v1, s[24:27], s64 offen offset:2048 sc1
  buffer_load_dwordx4 v[124:127], v1, s[24:27], s64 offen offset:3072 sc1
  buffer_load_dwordx4 v[128:131], v1, s[24:27], s65 offen  sc1
  buffer_load_dwordx4 v[132:135], v1, s[24:27], s65 offen offset:1024 sc1
  s_xor_b32 s60, s50, 1
  s_mul_i32 s60, s60, 12288
  s_add_u32 s60, s60, 106496
  v_add_u32 v28, s60, v1
  s_xor_b32 s60, s50, 2
  s_mul_i32 s60, s60, 12288
  s_add_u32 s60, s60, 110592
  v_add_u32 v29, s60, v1
  s_xor_b32 s60, s50, 3
  s_mul_i32 s60, s60, 12288
  s_add_u32 s60, s60, 114688
  v_add_u32 v30, s60, v1
  s_mul_i32 s60, s50, 12288
  s_add_u32 s60, s60, 106496
  v_add_u32 v27, s60, v1
  v_lshlrev_b32 v80, 16, v16
  v_and_b32 v81, 0xffff0000, v16
  v_lshlrev_b32 v82, 16, v17
  v_and_b32 v83, 0xffff0000, v17
  v_lshlrev_b32 v84, 16, v18
  v_and_b32 v85, 0xffff0000, v18
  v_lshlrev_b32 v86, 16, v19
  v_and_b32 v87, 0xffff0000, v19
  v_lshlrev_b32 v88, 16, v20
  v_and_b32 v89, 0xffff0000, v20
  v_lshlrev_b32 v90, 16, v21
  v_and_b32 v91, 0xffff0000, v21
  v_lshlrev_b32 v92, 16, v22
  v_and_b32 v93, 0xffff0000, v22
  v_lshlrev_b32 v94, 16, v23
  v_and_b32 v95, 0xffff0000, v23
  s_mul_i32 s62, s50, 10
  s_add_u32 s62, s62, 0
  s_mul_i32 s63, s62, 28672
  s_lshl_b32 s62, s62, 10
  s_add_u32 s62, s62, 65536
  s_lshl_b32 s61, s49, 8
  s_add_u32 s63, s63, s61
  s_add_u32 s63, s63, 128
  s_mov_b32 m0, s62
  s_mov_b32 s60, s63
  s_waitcnt vmcnt(9)
  v_mfma_f32_32x32x16_bf16 v[32:47], a[224:227], v[96:99], 0
  buffer_load_dwordx4 v[136:139], v1, s[24:27], s65 offen offset:2048 sc1
  v_mfma_f32_32x32x16_bf16 v[48:63], a[228:231], v[96:99], 0
  s_waitcnt vmcnt(9)
  v_mfma_f32_32x32x16_bf16 v[32:47], a[232:235], v[100:103], v[32:47]
  buffer_load_dwordx4 v[140:143], v1, s[24:27], s65 offen offset:3072 sc1
  v_mfma_f32_32x32x16_bf16 v[48:63], a[236:239], v[100:103], v[48:63]
  s_waitcnt vmcnt(9)
  v_mfma_f32_32x32x16_bf16 v[32:47], a[240:243], v[104:107], v[32:47]
  s_add_u32 s65, s65, 4096
  buffer_load_dwordx4 v[144:147], v1, s[24:27], s65 offen  sc1
  v_mfma_f32_32x32x16_bf16 v[48:63], a[244:247], v[104:107], v[48:63]
  s_waitcnt vmcnt(9)
  v_mfma_f32_32x32x16_bf16 v[32:47], a[248:251], v[108:111], v[32:47]
  buffer_load_dwordx4 v[148:151], v1, s[24:27], s65 offen offset:1024 sc1
  v_mfma_f32_32x32x16_bf16 v[48:63], a[252:255], v[108:111], v[48:63]
  s_waitcnt vmcnt(9)
  v_mfma_f32_32x32x16_bf16 v[32:47], v[224:227], v[112:115], v[32:47]
  buffer_load_dwordx4 v[152:155], v1, s[24:27], s65 offen offset:2048 sc1
  v_mfma_f32_32x32x16_bf16 v[48:63], v[228:231], v[112:115], v[48:63]
  s_waitcnt vmcnt(9)
  v_mfma_f32_32x32x16_bf16 v[32:47], v[232:235], v[116:119], v[32:47]
  buffer_load_dwordx4 v[156:159], v1, s[24:27], s65 offen offset:3072 sc1
  v_mfma_f32_32x32x16_bf16 v[48:63], v[236:239], v[116:119], v[48:63]
  s_waitcnt vmcnt(9)
  v_mfma_f32_32x32x16_bf16 v[32:47], v[240:243], v[120:123], v[32:47]
  buffer_load_dwordx4 v5, s[16:19], s60 offen  lds
  s_add_u32 m0, m0, 1024
  s_add_u32 s60, s60, 28672
  v_mfma_f32_32x32x16_bf16 v[48:63], v[244:247], v[120:123], v[48:63]
  s_waitcnt vmcnt(9)
  v_mfma_f32_32x32x16_bf16 v[32:47], v[248:251], v[124:127], v[32:47]
  buffer_load_dwordx4 v5, s[16:19], s60 offen  lds
  s_add_u32 m0, m0, 1024
  s_add_u32 s60, s60, 28672
  v_mfma_f32_32x32x16_bf16 v[48:63], v[252:255], v[124:127], v[48:63]
  s_waitcnt vmcnt(9)
  v_mfma_f32_32x32x16_bf16 v[64:79], a[228:231], v[128:131], 0
  buffer_load_dwordx4 v5, s[16:19], s60 offen  lds
  s_add_u32 m0, m0, 1024
  s_add_u32 s60, s60, 28672
  v_mfma_f32_32x32x16_bf16 v[80:95], a[224:227], v[128:131], v[80:95]
  s_waitcnt vmcnt(9)
  v_mfma_f32_32x32x16_bf16 v[64:79], a[236:239], v[132:135], v[64:79]
  buffer_load_dwordx4 v5, s[16:19], s60 offen  lds
  s_add_u32 m0, m0, 1024
  s_add_u32 s60, s60, 28672
  v_mfma_f32_32x32x16_bf16 v[80:95], a[232:235], v[132:135], v[80:95]
  s_waitcnt vmcnt(9)
  v_mfma_f32_32x32x16_bf16 v[64:79], a[244:247], v[136:139], v[64:79]
  ds_write_b128 v29, v[32:35] offset:0
  buffer_load_dwordx4 v5, s[16:19], s60 offen  lds
  s_add_u32 m0, m0, 1024
  s_add_u32 s60, s60, 28672
  v_mfma_f32_32x32x16_bf16 v[80:95], a[240:243], v[136:139], v[80:95]
  ds_write_b128 v29, v[36:39] offset:1024
  s_waitcnt vmcnt(9)
  v_mfma_f32_32x32x16_bf16 v[64:79], a[252:255], v[140:143], v[64:79]
  ds_write_b128 v29, v[40:43] offset:2048
  buffer_load_dwordx4 v5, s[16:19], s60 offen  lds
  s_add_u32 m0, m0, 1024
  s_add_u32 s60, s60, 28672
  v_mfma_f32_32x32x16_bf16 v[80:95], a[248:251], v[140:143], v[80:95]
  ds_write_b128 v29, v[44:47] offset:3072
  s_waitcnt vmcnt(9)
  v_mfma_f32_32x32x16_bf16 v[64:79], v[228:231], v[144:147], v[64:79]
  ds_write_b128 v30, v[48:51] offset:0
  buffer_load_dwordx4 v5, s[16:19], s60 offen  lds
  s_add_u32 m0, m0, 1024
  s_add_u32 s60, s60, 28672
  v_mfma_f32_32x32x16_bf16 v[80:95], v[224:227], v[144:147], v[80:95]
  ds_write_b128 v30, v[52:55] offset:1024
  s_waitcnt vmcnt(9)
  v_mfma_f32_32x32x16_bf16 v[64:79], v[236:239], v[148:151], v[64:79]
  ds_write_b128 v30, v[56:59] offset:2048
  buffer_load_dwordx4 v5, s[16:19], s60 offen  lds
  s_add_u32 m0, m0, 1024
  s_add_u32 s60, s60, 28672
  v_mfma_f32_32x32x16_bf16 v[80:95], v[232:235], v[148:151], v[80:95]
  ds_write_b128 v30, v[60:63] offset:3072
  s_waitcnt vmcnt(9)
  v_mfma_f32_32x32x16_bf16 v[64:79], v[244:247], v[152:155], v[64:79]
  buffer_load_dwordx4 v5, s[16:19], s60 offen  lds
  s_add_u32 m0, m0, 1024
  s_add_u32 s60, s60, 28672
  v_mfma_f32_32x32x16_bf16 v[80:95], v[240:243], v[152:155], v[80:95]
  s_waitcnt vmcnt(9)
  v_mfma_f32_32x32x16_bf16 v[64:79], v[252:255], v[156:159], v[64:79]
  buffer_load_dwordx4 v5, s[16:19], s60 offen  lds
  s_add_u32 m0, m0, 1024
  s_add_u32 s60, s60, 28672
  v_mfma_f32_32x32x16_bf16 v[80:95], v[248:251], v[156:159], v[80:95]
  s_nop 7
  ds_write_b128 v28, v[64:67] offset:0
  ds_write_b128 v28, v[68:71] offset:1024
  ds_write_b128 v28, v[72:75] offset:2048
  ds_write_b128 v28, v[76:79] offset:3072
  s_waitcnt lgkmcnt(0)
  s_barrier
  ds_read_b128 v[32:35], v27 offset:0
  ds_read_b128 v[36:39], v27 offset:1024
  ds_read_b128 v[40:43], v27 offset:2048
  ds_read_b128 v[44:47], v27 offset:3072
  ds_read_b128 v[48:51], v27 offset:4096
  ds_read_b128 v[52:55], v27 offset:5120
  ds_read_b128 v[56:59], v27 offset:6144
  ds_read_b128 v[60:63], v27 offset:7168
  ds_read_b128 v[64:67], v27 offset:8192
  ds_read_b128 v[68:71], v27 offset:9216
  ds_read_b128 v[72:75], v27 offset:10240
  ds_read_b128 v[76:79], v27 offset:11264
  s_waitcnt lgkmcnt(11)
  v_pk_add_f32 v[80:81], v[80:81], v[32:33]
  v_pk_add_f32 v[82:83], v[82:83], v[34:35]
  s_waitcnt lgkmcnt(10)
  v_pk_add_f32 v[84:85], v[84:85], v[36:37]
  v_pk_add_f32 v[86:87], v[86:87], v[38:39]
  s_waitcnt lgkmcnt(9)
  v_pk_add_f32 v[88:89], v[88:89], v[40:41]
  v_pk_add_f32 v[90:91], v[90:91], v[42:43]
  s_waitcnt lgkmcnt(8)
  v_pk_add_f32 v[92:93], v[92:93], v[44:45]
  v_pk_add_f32 v[94:95], v[94:95], v[46:47]
  s_waitcnt lgkmcnt(7)
  v_pk_add_f32 v[80:81], v[80:81], v[48:49]
  v_pk_add_f32 v[82:83], v[82:83], v[50:51]
  s_waitcnt lgkmcnt(6)
  v_pk_add_f32 v[84:85], v[84:85], v[52:53]
  v_pk_add_f32 v[86:87], v[86:87], v[54:55]
  s_waitcnt lgkmcnt(5)
  v_pk_add_f32 v[88:89], v[88:89], v[56:57]
  v_pk_add_f32 v[90:91], v[90:91], v[58:59]
  s_waitcnt lgkmcnt(4)
  v_pk_add_f32 v[92:93], v[92:93], v[60:61]
  v_pk_add_f32 v[94:95], v[94:95], v[62:63]
  s_waitcnt lgkmcnt(3)
  v_pk_add_f32 v[80:81], v[80:81], v[64:65]
  v_pk_add_f32 v[82:83], v[82:83], v[66:67]
  s_waitcnt lgkmcnt(2)
  v_pk_add_f32 v[84:85], v[84:85], v[68:69]
  v_pk_add_f32 v[86:87], v[86:87], v[70:71]
  s_waitcnt lgkmcnt(1)
  v_pk_add_f32 v[88:89], v[88:89], v[72:73]
  v_pk_add_f32 v[90:91], v[90:91], v[74:75]
  s_waitcnt lgkmcnt(0)
  v_pk_add_f32 v[92:93], v[92:93], v[76:77]
  v_pk_add_f32 v[94:95], v[94:95], v[78:79]
  v_cvt_pk_bf16_f32 v16, v80, v81
  v_cvt_pk_bf16_f32 v17, v82, v83
  v_cvt_pk_bf16_f32 v18, v84, v85
  v_cvt_pk_bf16_f32 v19, v86, v87
  v_cvt_pk_bf16_f32 v20, v88, v89
  v_cvt_pk_bf16_f32 v21, v90, v91
  v_cvt_pk_bf16_f32 v22, v92, v93
  v_cvt_pk_bf16_f32 v23, v94, v95
  buffer_store_dwordx4 v[16:19], v1, s[24:27], s96 offen
  buffer_store_dwordx4 v[20:23], v1, s[24:27], s96 offen offset:1024
  v_mov_b32 v24, 0
  v_mov_b32 v25, 0
  v_mov_b32 v26, 0
  v_mov_b32 v27, 0
  v_dot2c_f32_bf16 v24, s93, v16
  v_dot2c_f32_bf16 v25, v16, v16
  v_dot2c_f32_bf16 v26, s93, v17
  v_dot2c_f32_bf16 v27, v17, v17
  v_dot2c_f32_bf16 v24, s93, v18
  v_dot2c_f32_bf16 v25, v18, v18
  v_dot2c_f32_bf16 v26, s93, v19
  v_dot2c_f32_bf16 v27, v19, v19
  v_dot2c_f32_bf16 v24, s93, v20
  v_dot2c_f32_bf16 v25, v20, v20
  v_dot2c_f32_bf16 v26, s93, v21
  v_dot2c_f32_bf16 v27, v21, v21
  v_dot2c_f32_bf16 v24, s93, v22
  v_dot2c_f32_bf16 v25, v22, v22
  v_dot2c_f32_bf16 v26, s93, v23
  v_dot2c_f32_bf16 v27, v23, v23
  s_nop 2
  v_pk_add_f32 v[24:25], v[24:25], v[26:27]
  v_mov_b32 v26, v24
  v_mov_b32 v27, v25
  s_nop 0
  v_permlane32_swap_b32 v24, v26
  v_permlane32_swap_b32 v25, v27
  s_nop 1
  v_pk_add_f32 v[24:25], v[24:25], v[26:27]
  s_mov_b64 exec, s[78:79]
  buffer_store_dwordx2 v[24:25], v1, s[24:27], s97 offen
  s_mov_b64 exec, -1
  s_add_u32 s60, s83, 256
  s_cmp_lg_u32 s52, 0
  s_waitcnt vmcnt(0)
  s_mov_b64 exec, 1
  s_cbranch_scc1 SL14
  buffer_store_dword v3, off, s[24:27], s60
DN15:
  s_mov_b64 exec, -1
  s_barrier
  s_cmp_eq_u32 s51, 1
  s_cselect_b32 s10, 0, s10
  s_cmp_ge_u32 s49, 14
  s_cbranch_scc1 SKIP3
  s_mul_i32 s62, s50, 6
  s_add_u32 s62, s62, 40
  s_mul_i32 s63, s62, 28672
  s_lshl_b32 s62, s62, 10
  s_add_u32 s62, s62, 65536
  s_lshl_b32 s61, s49, 8
  s_add_u32 s63, s63, s61
  s_add_u32 s63, s63, 128
  s_mov_b32 m0, s62
  s_mov_b32 s60, s63
  s_add_u32 s61, s60, 172032
L16:
  buffer_load_dwordx4 v5, s[16:19], s60 offen  lds
  s_add_u32 m0, m0, 1024
  s_add_u32 s60, s60, 28672
  s_cmp_lg_u32 s60, s61
  s_cbranch_scc1 L16
  s_add_u32 s60, s82, 256
  s_mov_b32 s61, 200000
  s_cmp_lg_u32 s51, 0
  s_cbranch_scc1 L17
  s_and_b32 s66, s50, 1
  s_lshr_b32 s62, s50, 1
  s_lshl_b32 s64, s49, 8
  s_lshl_b32 s63, s66, 6
  s_add_u32 s64, s64, s63
  v_bfe_u32 v25, v6, 1, 6
  buffer_load_ushort v26, v25, s[40:43], s64 offen offset:128
  s_mul_i32 s64, s62, 20480
  s_lshl_b32 s63, s66, 9
  s_add_u32 s64, s64, s63
  v_add_u32 v25, s64, v3
  s_lshl_b32 s67, s66, 10
  s_add_u32 s67, s67, 5120
  s_lshl_b32 s64, s62, 13
  s_sub_u32 s64, 40960, s64
  v_add_u32 v64, s64, v25
  s_lshl_b32 s62, s62, 5
  s_lshl_b64 s[64:65], s[78:79], s62
  v_mov_b32 v28, 0
  v_mov_b32 v29, 0
  v_mov_b32 v30, 0
  v_mov_b32 v31, 0
  v_add_u32 v27, s67, v7
  ds_read_b64_tr_b16 v[32:33], v25 offset:0
  ds_read_b64_tr_b16 v[34:35], v25 offset:1024
  ds_read_b64_tr_b16 v[36:37], v25 offset:2048
  ds_read_b64_tr_b16 v[38:39], v25 offset:3072
  ds_read_b64_tr_b16 v[40:41], v25 offset:4096
  ds_read_b64_tr_b16 v[42:43], v25 offset:5120
  ds_read_b64_tr_b16 v[44:45], v25 offset:6144
  ds_read_b64_tr_b16 v[46:47], v25 offset:7168
  ds_read_b64_tr_b16 v[48:49], v25 offset:8192
  ds_read_b64_tr_b16 v[50:51], v25 offset:9216
  ds_read_b64_tr_b16 v[52:53], v25 offset:10240
  ds_read_b64_tr_b16 v[54:55], v25 offset:11264
  ds_read_b64_tr_b16 v[56:57], v25 offset:12288
  ds_read_b64_tr_b16 v[58:59], v25 offset:13312
  s_waitcnt lgkmcnt(12)
  v_dot2c_f32_bf16 v28, s93, v32
  v_dot2c_f32_bf16 v29, s93, v33
  v_dot2c_f32_bf16 v30, s93, v34
  v_dot2c_f32_bf16 v31, s93, v35
  ds_read_b64_tr_b16 v[60:61], v25 offset:14336
  ds_read_b64_tr_b16 v[62:63], v25 offset:15360
  s_waitcnt lgkmcnt(12)
  v_dot2c_f32_bf16 v28, s93, v36
  v_dot2c_f32_bf16 v29, s93, v37
  v_dot2c_f32_bf16 v30, s93, v38
  v_dot2c_f32_bf16 v31, s93, v39
  ds_read_b64_tr_b16 v[32:33], v25 offset:16384
  ds_read_b64_tr_b16 v[34:35], v25 offset:17408
  s_waitcnt lgkmcnt(12)
  v_dot2c_f32_bf16 v28, s93, v40
  v_dot2c_f32_bf16 v29, s93, v41
  v_dot2c_f32_bf16 v30, s93, v42
  v_dot2c_f32_bf16 v31, s93, v43
  ds_read_b64_tr_b16 v[36:37], v25 offset:18432
  ds_read_b64_tr_b16 v[38:39], v25 offset:19456
  s_waitcnt lgkmcnt(12)
  v_dot2c_f32_bf16 v28, s93, v44
  v_dot2c_f32_bf16 v29, s93, v45
  v_dot2c_f32_bf16 v30, s93, v46
  v_dot2c_f32_bf16 v31, s93, v47
  s_waitcnt lgkmcnt(10)
  v_dot2c_f32_bf16 v28, s93, v48
  v_dot2c_f32_bf16 v29, s93, v49
  v_dot2c_f32_bf16 v30, s93, v50
  v_dot2c_f32_bf16 v31, s93, v51
  s_waitcnt lgkmcnt(8)
  v_dot2c_f32_bf16 v28, s93, v52
  v_dot2c_f32_bf16 v29, s93, v53
  v_dot2c_f32_bf16 v30, s93, v54
  v_dot2c_f32_bf16 v31, s93, v55
  s_waitcnt lgkmcnt(6)
  v_dot2c_f32_bf16 v28, s93, v56
  v_dot2c_f32_bf16 v29, s93, v57
  v_dot2c_f32_bf16 v30, s93, v58
  v_dot2c_f32_bf16 v31, s93, v59
  s_waitcnt lgkmcnt(4)
  v_dot2c_f32_bf16 v28, s93, v60
  v_dot2c_f32_bf16 v29, s93, v61
  v_dot2c_f32_bf16 v30, s93, v62
  v_dot2c_f32_bf16 v31, s93, v63
  s_waitcnt lgkmcnt(2)
  v_dot2c_f32_bf16 v28, s93, v32
  v_dot2c_f32_bf16 v29, s93, v33
  v_dot2c_f32_bf16 v30, s93, v34
  v_dot2c_f32_bf16 v31, s93, v35
  s_waitcnt lgkmcnt(0)
  v_dot2c_f32_bf16 v28, s93, v36
  v_dot2c_f32_bf16 v29, s93, v37
  v_dot2c_f32_bf16 v30, s93, v38
  v_dot2c_f32_bf16 v31, s93, v39
  s_waitcnt vmcnt(0)
  s_barrier
  ds_read_b64_tr_b16 v[40:41], v64 offset:0
  ds_read_b64_tr_b16 v[42:43], v64 offset:1024
  ds_read_b64_tr_b16 v[44:45], v64 offset:2048
  ds_read_b64_tr_b16 v[46:47], v64 offset:3072
  ds_read_b64_tr_b16 v[48:49], v64 offset:4096
  ds_read_b64_tr_b16 v[50:51], v64 offset:5120
  ds_read_b64_tr_b16 v[52:53], v64 offset:6144
  ds_read_b64_tr_b16 v[54:55], v64 offset:7168
  ds_read_b64_tr_b16 v[56:57], v64 offset:8192
  ds_read_b64_tr_b16 v[58:59], v64 offset:9216
  ds_read_b64_tr_b16 v[60:61], v64 offset:10240
  ds_read_b64_tr_b16 v[62:63], v64 offset:11264
  buffer_load_dword v24, v6, s[24:27], s60 offen sc1
  s_waitcnt lgkmcnt(10)
  v_dot2c_f32_bf16 v28, s93, v40
  v_dot2c_f32_bf16 v29, s93, v41
  v_dot2c_f32_bf16 v30, s93, v42
  v_dot2c_f32_bf16 v31, s93, v43
  s_waitcnt lgkmcnt(8)
  v_dot2c_f32_bf16 v28, s93, v44
  v_dot2c_f32_bf16 v29, s93, v45
  v_dot2c_f32_bf16 v30, s93, v46
  v_dot2c_f32_bf16 v31, s93, v47
  s_waitcnt lgkmcnt(6)
  v_dot2c_f32_bf16 v28, s93, v48
  v_dot2c_f32_bf16 v29, s93, v49
  v_dot2c_f32_bf16 v30, s93, v50
  v_dot2c_f32_bf16 v31, s93, v51
  s_waitcnt lgkmcnt(4)
  v_dot2c_f32_bf16 v28, s93, v52
  v_dot2c_f32_bf16 v29, s93, v53
  v_dot2c_f32_bf16 v30, s93, v54
  v_dot2c_f32_bf16 v31, s93, v55
  s_waitcnt lgkmcnt(2)
  v_dot2c_f32_bf16 v28, s93, v56
  v_dot2c_f32_bf16 v29, s93, v57
  v_dot2c_f32_bf16 v30, s93, v58
  v_dot2c_f32_bf16 v31, s93, v59
  s_waitcnt lgkmcnt(0)
  v_dot2c_f32_bf16 v28, s93, v60
  v_dot2c_f32_bf16 v29, s93, v61
  v_dot2c_f32_bf16 v30, s93, v62
  v_dot2c_f32_bf16 v31, s93, v63
  s_nop 2
  v_pk_add_f32 v[28:29], v[28:29], v[30:31]
  v_add_f32 v32, v28, v29
  v_mov_b32 v33, v32
  s_nop 1
  v_permlane32_swap_b32 v32, v33
  s_nop 1
  v_add_f32 v32, v32, v33
  v_cvt_pk_bf16_f32 v28, v32, v32
  v_and_b32 v28, 0xffff0000, v28
  v_sub_f32 v28, v32, v28
  v_cvt_pk_bf16_f32 v28, -v32, -v28
  v_and_b32 v29, 0xffff, v28
  v_mov_b32 v31, 0
  s_waitcnt vmcnt(1)
  v_lshl_or_b32 v29, v26, 16, v29
  v_mov_b32 v30, v26
  s_mov_b64 exec, s[64:65]
  ds_write_b128 v27, v[28:31]
  s_mov_b64 exec, -1
  s_waitcnt lgkmcnt(0)
  s_branch DN18
L17:
  buffer_load_dword v24, v6, s[24:27], s60 offen sc1
DN18:
  s_sub_u32 s61, s61, 1
  s_cbranch_scc1 FIN
  s_waitcnt vmcnt(0)
  v_cmp_ne_u32 vcc, 0, v24
  s_and_b64 s[62:63], vcc, s[70:71]
  s_cmp_eq_u64 s[62:63], s[70:71]
  s_cbranch_scc0 L17
  s_cmp_lg_u32 s52, 0
  s_cbranch_scc1 SL19
DN20:
  s_lshl_b32 s65, s50, 12
  s_add_u32 s65, s65, 720896
  s_lshl_b32 s64, s50, 15
  buffer_load_dwordx4 v[96:99], v1, s[24:27], s64 offen  sc1
  buffer_load_dwordx4 v[100:103], v1, s[24:27], s64 offen offset:1024 sc1
  buffer_load_dwordx4 v[208:211], v1, s[24:27], s65 offen  sc1
  buffer_load_dwordx4 v[212:215], v1, s[24:27], s65 offen offset:1024 sc1
  buffer_load_dwordx4 v[216:219], v1, s[24:27], s65 offen offset:2048 sc1
  buffer_load_dwordx4 v[220:223], v1, s[24:27], s65 offen offset:3072 sc1
  buffer_load_dwordx4 v[104:107], v1, s[24:27], s64 offen offset:2048 sc1
  buffer_load_dwordx4 v[108:111], v1, s[24:27], s64 offen offset:3072 sc1
  s_add_u32 s64, s64, 4096
  buffer_load_dwordx4 v[112:115], v1, s[24:27], s64 offen  sc1
  buffer_load_dwordx4 v[116:119], v1, s[24:27], s64 offen offset:1024 sc1
  buffer_load_dwordx4 v[120:123], v1, s[24:27], s64 offen offset:2048 sc1
  buffer_load_dwordx4 v[124:127], v1, s[24:27], s64 offen offset:3072 sc1
  ds_read_b64_tr_b16 v[16:17], v2 offset:0
  ds_read_b64_tr_b16 v[18:19], v2 offset:1024
  ds_read_b64_tr_b16 v[20:21], v2 offset:512
  ds_read_b64_tr_b16 v[22:23], v2 offset:1536
  ds_read_b64_tr_b16 v[24:25], v3 offset:0
  ds_read_b64_tr_b16 v[26:27], v3 offset:1024
  ds_read_b64_tr_b16 v[28:29], v2 offset:2048
  ds_read_b64_tr_b16 v[30:31], v2 offset:3072
  ds_read_b64_tr_b16 v[80:81], v2 offset:2560
  ds_read_b64_tr_b16 v[82:83], v2 offset:3584
  ds_read_b64_tr_b16 v[84:85], v3 offset:2048
  ds_read_b64_tr_b16 v[86:87], v3 offset:3072
  s_waitcnt lgkmcnt(6) vmcnt(11)
  v_mfma_f32_32x32x16_bf16 v[32:47], v[16:19], v[96:99], 0
  ds_read_b64_tr_b16 v[88:89], v2 offset:4096
  ds_read_b64_tr_b16 v[90:91], v2 offset:5120
  s_add_u32 s64, s64, 4096
  buffer_load_dwordx4 v[128:131], v1, s[24:27], s64 offen  sc1
  v_mfma_f32_32x32x16_bf16 v[48:63], v[20:23], v[96:99], 0
  ds_read_b64_tr_b16 v[92:93], v2 offset:4608
  ds_read_b64_tr_b16 v[94:95], v2 offset:5632
  v_mfma_f32_32x32x16_bf16 v[64:79], v[24:27], v[96:99], 0
  ds_read_b64_tr_b16 v[16:17], v3 offset:4096
  ds_read_b64_tr_b16 v[18:19], v3 offset:5120
  s_waitcnt lgkmcnt(6) vmcnt(11)
  v_mfma_f32_32x32x16_bf16 v[32:47], v[28:31], v[100:103], v[32:47]
  ds_read_b64_tr_b16 v[20:21], v2 offset:6144
  ds_read_b64_tr_b16 v[22:23], v2 offset:7168
  buffer_load_dwordx4 v[132:135], v1, s[24:27], s64 offen offset:1024 sc1
  v_mfma_f32_32x32x16_bf16 v[48:63], v[80:83], v[100:103], v[48:63]
  ds_read_b64_tr_b16 v[24:25], v2 offset:6656
  ds_read_b64_tr_b16 v[26:27], v2 offset:7680
  v_mfma_f32_32x32x16_bf16 v[64:79], v[84:87], v[100:103], v[64:79]
  ds_read_b64_tr_b16 v[28:29], v3 offset:6144
  ds_read_b64_tr_b16 v[30:31], v3 offset:7168
  s_waitcnt lgkmcnt(6) vmcnt(7)
  v_mfma_f32_32x32x16_bf16 v[32:47], v[88:91], v[104:107], v[32:47]
  ds_read_b64_tr_b16 v[80:81], v2 offset:8192
  ds_read_b64_tr_b16 v[82:83], v2 offset:9216
  buffer_load_dwordx4 v[136:139], v1, s[24:27], s64 offen offset:2048 sc1
  v_mfma_f32_32x32x16_bf16 v[48:63], v[92:95], v[104:107], v[48:63]
  ds_read_b64_tr_b16 v[84:85], v2 offset:8704
  ds_read_b64_tr_b16 v[86:87], v2 offset:9728
  v_add_f32 v222, v222, v208
  v_add_f32 v223, v223, v209
  v_mfma_f32_32x32x16_bf16 v[64:79], v[16:19], v[104:107], v[64:79]
  ds_read_b64_tr_b16 v[88:89], v3 offset:8192
  ds_read_b64_tr_b16 v[90:91], v3 offset:9216
  v_add_f32 v222, v222, v210
  v_add_f32 v223, v223, v211
  s_waitcnt lgkmcnt(6) vmcnt(7)
  v_mfma_f32_32x32x16_bf16 v[32:47], v[20:23], v[108:111], v[32:47]
  ds_read_b64_tr_b16 v[92:93], v2 offset:10240
  ds_read_b64_tr_b16 v[94:95], v2 offset:11264
  buffer_load_dwordx4 v[140:143], v1, s[24:27], s64 offen offset:3072 sc1
  v_mfma_f32_32x32x16_bf16 v[48:63], v[24:27], v[108:111], v[48:63]
  ds_read_b64_tr_b16 v[16:17], v2 offset:10752
  ds_read_b64_tr_b16 v[18:19], v2 offset:11776
  v_add_f32 v222, v222, v212
  v_add_f32 v223, v223, v213
  v_mfma_f32_32x32x16_bf16 v[64:79], v[28:31], v[108:111], v[64:79]
  ds_read_b64_tr_b16 v[20:21], v3 offset:10240
  ds_read_b64_tr_b16 v[22:23], v3 offset:11264
  v_add_f32 v222, v222, v214
  v_add_f32 v223, v223, v215
  s_waitcnt lgkmcnt(6) vmcnt(7)
  v_mfma_f32_32x32x16_bf16 v[32:47], v[80:83], v[112:115], v[32:47]
  ds_read_b64_tr_b16 v[24:25], v2 offset:12288
  ds_read_b64_tr_b16 v[26:27], v2 offset:13312
  s_add_u32 s64, s64, 4096
  buffer_load_dwordx4 v[144:147], v1, s[24:27], s64 offen  sc1
  v_mfma_f32_32x32x16_bf16 v[48:63], v[84:87], v[112:115], v[48:63]
  ds_read_b64_tr_b16 v[28:29], v2 offset:12800
  ds_read_b64_tr_b16 v[30:31], v2 offset:13824
  v_add_f32 v222, v222, v216
  v_add_f32 v223, v223, v217
  v_mfma_f32_32x32x16_bf16 v[64:79], v[88:91], v[112:115], v[64:79]
  ds_read_b64_tr_b16 v[80:81], v3 offset:12288
  ds_read_b64_tr_b16 v[82:83], v3 offset:13312
  v_add_f32 v222, v222, v218
  v_add_f32 v223, v223, v219
  s_waitcnt lgkmcnt(6) vmcnt(7)
  v_mfma_f32_32x32x16_bf16 v[32:47], v[92:95], v[116:119], v[32:47]
  ds_read_b64_tr_b16 v[84:85], v2 offset:14336
  ds_read_b64_tr_b16 v[86:87], v2 offset:15360
  buffer_load_dwordx4 v[148:151], v1, s[24:27], s64 offen offset:1024 sc1
  v_mfma_f32_32x32x16_bf16 v[48:63], v[16:19], v[116:119], v[48:63]
  ds_read_b64_tr_b16 v[88:89], v2 offset:14848
  ds_read_b64_tr_b16 v[90:91], v2 offset:15872
  v_add_f32 v222, v222, v220
  v_add_f32 v223, v223, v221
  v_mfma_f32_32x32x16_bf16 v[64:79], v[20:23], v[116:119], v[64:79]
  ds_read_b64_tr_b16 v[92:93], v3 offset:14336
  ds_read_b64_tr_b16 v[94:95], v3 offset:15360
  v_mov_b32 v220, v222
  v_mov_b32 v221, v223
  s_waitcnt lgkmcnt(6) vmcnt(7)
  v_mfma_f32_32x32x16_bf16 v[32:47], v[24:27], v[120:123], v[32:47]
  ds_read_b64_tr_b16 v[16:17], v2 offset:16384
  ds_read_b64_tr_b16 v[18:19], v2 offset:17408
  buffer_load_dwordx4 v[152:155], v1, s[24:27], s64 offen offset:2048 sc1
  v_mfma_f32_32x32x16_bf16 v[48:63], v[28:31], v[120:123], v[48:63]
  ds_read_b64_tr_b16 v[20:21], v2 offset:16896
  ds_read_b64_tr_b16 v[22:23], v2 offset:17920
  v_permlane32_swap_b32 v222, v220
  v_permlane32_swap_b32 v223, v221
  v_mfma_f32_32x32x16_bf16 v[64:79], v[80:83], v[120:123], v[64:79]
  ds_read_b64_tr_b16 v[24:25], v3 offset:16384
  ds_read_b64_tr_b16 v[26:27], v3 offset:17408
  s_nop 1
  v_add_f32 v222, v222, v220
  s_waitcnt lgkmcnt(6) vmcnt(7)
  v_mfma_f32_32x32x16_bf16 v[32:47], v[84:87], v[124:127], v[32:47]
  ds_read_b64_tr_b16 v[28:29], v2 offset:18432
  ds_read_b64_tr_b16 v[30:31], v2 offset:19456
  buffer_load_dwordx4 v[156:159], v1, s[24:27], s64 offen offset:3072 sc1
  v_mfma_f32_32x32x16_bf16 v[48:63], v[88:91], v[124:127], v[48:63]
  ds_read_b64_tr_b16 v[80:81], v2 offset:18944
  ds_read_b64_tr_b16 v[82:83], v2 offset:19968
  v_add_f32 v223, v223, v221
  v_mul_f32 v222, 0x3b000000, v222
  v_mfma_f32_32x32x16_bf16 v[64:79], v[92:95], v[124:127], v[64:79]
  ds_read_b64_tr_b16 v[84:85], v3 offset:18432
  ds_read_b64_tr_b16 v[86:87], v3 offset:19456
  v_mul_f32 v223, 0x3b000000, v223
  v_fma_f32 v223, -v222, v222, v223
  s_waitcnt lgkmcnt(6) vmcnt(7)
  v_mfma_f32_32x32x16_bf16 v[32:47], v[16:19], v[128:131], v[32:47]
  ds_read_b64_tr_b16 v[88:89], v2 offset:20480
  ds_read_b64_tr_b16 v[90:91], v2 offset:21504
  s_add_u32 s64, s64, 4096
  buffer_load_dwordx4 v[160:163], v1, s[24:27], s64 offen  sc1
  v_mfma_f32_32x32x16_bf16 v[48:63], v[20:23], v[128:131], v[48:63]
  ds_read_b64_tr_b16 v[92:93], v2 offset:20992
  ds_read_b64_tr_b16 v[94:95], v2 offset:22016
  v_max_f32 v223, 0, v223
  v_add_f32 v220, 0x3727c5ac, v223
  v_mfma_f32_32x32x16_bf16 v[64:79], v[24:27], v[128:131], v[64:79]
  ds_read_b64_tr_b16 v[16:17], v3 offset:20480
  ds_read_b64_tr_b16 v[18:19], v3 offset:21504
  v_rsq_f32 v13, v220
  s_nop 0
  v_mul_f32 v223, v223, v13
  s_waitcnt lgkmcnt(6) vmcnt(7)
  v_mfma_f32_32x32x16_bf16 v[32:47], v[28:31], v[132:135], v[32:47]
  ds_read_b64_tr_b16 v[20:21], v2 offset:22528
  ds_read_b64_tr_b16 v[22:23], v2 offset:23552
  buffer_load_dwordx4 v[164:167], v1, s[24:27], s64 offen offset:1024 sc1
  v_mfma_f32_32x32x16_bf16 v[48:63], v[80:83], v[132:135], v[48:63]
  ds_read_b64_tr_b16 v[24:25], v2 offset:23040
  ds_read_b64_tr_b16 v[26:27], v2 offset:24064
  v_fmaak_f32 v223, v223, v13, 0x3727c5ac
  v_rsq_f32 v223, v223
  v_mfma_f32_32x32x16_bf16 v[64:79], v[84:87], v[132:135], v[64:79]
  ds_read_b64_tr_b16 v[28:29], v3 offset:22528
  ds_read_b64_tr_b16 v[30:31], v3 offset:23552
  v_mul_f32 v13, v13, v223
  v_rcp_f32 v15, v13
  s_waitcnt lgkmcnt(6) vmcnt(7)
  v_mfma_f32_32x32x16_bf16 v[32:47], v[88:91], v[136:139], v[32:47]
  ds_read_b64_tr_b16 v[80:81], v2 offset:24576
  ds_read_b64_tr_b16 v[82:83], v2 offset:25600
  buffer_load_dwordx4 v[168:171], v1, s[24:27], s64 offen offset:2048 sc1
  v_mfma_f32_32x32x16_bf16 v[48:63], v[92:95], v[136:139], v[48:63]
  ds_read_b64_tr_b16 v[84:85], v2 offset:25088
  ds_read_b64_tr_b16 v[86:87], v2 offset:26112
  v_mul_f32 v12, 0xc0135761, v13
  v_mul_f32 v14, v13, v13
  v_mfma_f32_32x32x16_bf16 v[64:79], v[16:19], v[136:139], v[64:79]
  ds_read_b64_tr_b16 v[88:89], v3 offset:24576
  ds_read_b64_tr_b16 v[90:91], v3 offset:25600
  v_mul_f32 v14, 0x3d372713, v14
  v_mul_f32 v14, v14, v12
  s_waitcnt lgkmcnt(6) vmcnt(7)
  v_mfma_f32_32x32x16_bf16 v[32:47], v[20:23], v[140:143], v[32:47]
  ds_read_b64_tr_b16 v[92:93], v2 offset:26624
  ds_read_b64_tr_b16 v[94:95], v2 offset:27648
  buffer_load_dwordx4 v[172:175], v1, s[24:27], s64 offen offset:3072 sc1
  v_mfma_f32_32x32x16_bf16 v[48:63], v[24:27], v[140:143], v[48:63]
  ds_read_b64_tr_b16 v[16:17], v2 offset:27136
  ds_read_b64_tr_b16 v[18:19], v2 offset:28160
  v_cndmask_b32 v223, 0, v15, s[78:79]
  v_cvt_pk_bf16_f32 v8, v222, v222
  v_mfma_f32_32x32x16_bf16 v[64:79], v[28:31], v[140:143], v[64:79]
  ds_read_b64_tr_b16 v[20:21], v3 offset:26624
  ds_read_b64_tr_b16 v[22:23], v3 offset:27648
  v_cvt_pk_bf16_f32 v10, v223, v223
  v_and_b32 v220, 0xffff0000, v8
  s_waitcnt lgkmcnt(6) vmcnt(7)
  v_mfma_f32_32x32x16_bf16 v[32:47], v[80:83], v[144:147], v[32:47]
  ds_read_b64_tr_b16 v[24:25], v2 offset:28672
  ds_read_b64_tr_b16 v[26:27], v2 offset:29696
  s_add_u32 s64, s64, 4096
  buffer_load_dwordx4 v[176:179], v1, s[24:27], s64 offen  sc1
  v_mfma_f32_32x32x16_bf16 v[48:63], v[84:87], v[144:147], v[48:63]
  ds_read_b64_tr_b16 v[28:29], v2 offset:29184
  ds_read_b64_tr_b16 v[30:31], v2 offset:30208
  v_and_b32 v221, 0xffff0000, v10
  v_sub_f32 v220, v222, v220
  v_mfma_f32_32x32x16_bf16 v[64:79], v[88:91], v[144:147], v[64:79]
  ds_read_b64_tr_b16 v[80:81], v3 offset:28672
  ds_read_b64_tr_b16 v[82:83], v3 offset:29696
  v_sub_f32 v221, v223, v221
  v_cvt_pk_bf16_f32 v9, v220, v223
  s_waitcnt lgkmcnt(6) vmcnt(7)
  v_mfma_f32_32x32x16_bf16 v[32:47], v[92:95], v[148:151], v[32:47]
  ds_read_b64_tr_b16 v[84:85], v2 offset:30720
  ds_read_b64_tr_b16 v[86:87], v2 offset:31744
  buffer_load_dwordx4 v[180:183], v1, s[24:27], s64 offen offset:1024 sc1
  v_mfma_f32_32x32x16_bf16 v[48:63], v[16:19], v[148:151], v[48:63]
  ds_read_b64_tr_b16 v[88:89], v2 offset:31232
  ds_read_b64_tr_b16 v[90:91], v2 offset:32256
  v_cvt_pk_bf16_f32 v10, v221, 0
  v_mov_b32 v11, 0
  v_mfma_f32_32x32x16_bf16 v[64:79], v[20:23], v[148:151], v[64:79]
  ds_read_b64_tr_b16 v[92:93], v3 offset:30720
  ds_read_b64_tr_b16 v[94:95], v3 offset:31744
  s_waitcnt lgkmcnt(6) vmcnt(7)
  v_mfma_f32_32x32x16_bf16 v[32:47], v[24:27], v[152:155], v[32:47]
  ds_read_b64_tr_b16 v[16:17], v2 offset:32768
  ds_read_b64_tr_b16 v[18:19], v2 offset:33792
  buffer_load_dwordx4 v[184:187], v1, s[24:27], s64 offen offset:2048 sc1
  v_mfma_f32_32x32x16_bf16 v[48:63], v[28:31], v[152:155], v[48:63]
  ds_read_b64_tr_b16 v[20:21], v2 offset:33280
  ds_read_b64_tr_b16 v[22:23], v2 offset:34304
  v_mfma_f32_32x32x16_bf16 v[64:79], v[80:83], v[152:155], v[64:79]
  ds_read_b64_tr_b16 v[24:25], v3 offset:32768
  ds_read_b64_tr_b16 v[26:27], v3 offset:33792
  s_waitcnt lgkmcnt(6) vmcnt(7)
  v_mfma_f32_32x32x16_bf16 v[32:47], v[84:87], v[156:159], v[32:47]
  ds_read_b64_tr_b16 v[28:29], v2 offset:34816
  ds_read_b64_tr_b16 v[30:31], v2 offset:35840
  buffer_load_dwordx4 v[188:191], v1, s[24:27], s64 offen offset:3072 sc1
  v_mfma_f32_32x32x16_bf16 v[48:63], v[88:91], v[156:159], v[48:63]
  ds_read_b64_tr_b16 v[80:81], v2 offset:35328
  ds_read_b64_tr_b16 v[82:83], v2 offset:36352
  v_mfma_f32_32x32x16_bf16 v[64:79], v[92:95], v[156:159], v[64:79]
  ds_read_b64_tr_b16 v[84:85], v3 offset:34816
  ds_read_b64_tr_b16 v[86:87], v3 offset:35840
  s_waitcnt lgkmcnt(6) vmcnt(7)
  v_mfma_f32_32x32x16_bf16 v[32:47], v[16:19], v[160:163], v[32:47]
  ds_read_b64_tr_b16 v[88:89], v2 offset:36864
  ds_read_b64_tr_b16 v[90:91], v2 offset:37888
  s_add_u32 s64, s64, 4096
  buffer_load_dwordx4 v[192:195], v1, s[24:27], s64 offen  sc1
  v_mfma_f32_32x32x16_bf16 v[48:63], v[20:23], v[160:163], v[48:63]
  ds_read_b64_tr_b16 v[92:93], v2 offset:37376
  ds_read_b64_tr_b16 v[94:95], v2 offset:38400
  v_mfma_f32_32x32x16_bf16 v[64:79], v[24:27], v[160:163], v[64:79]
  ds_read_b64_tr_b16 v[16:17], v3 offset:36864
  ds_read_b64_tr_b16 v[18:19], v3 offset:37888
  s_waitcnt lgkmcnt(6) vmcnt(7)
  v_mfma_f32_32x32x16_bf16 v[32:47], v[28:31], v[164:167], v[32:47]
  ds_read_b64_tr_b16 v[20:21], v2 offset:38912
  ds_read_b64_tr_b16 v[22:23], v2 offset:39936
  buffer_load_dwordx4 v[196:199], v1, s[24:27], s64 offen offset:1024 sc1
  v_mfma_f32_32x32x16_bf16 v[48:63], v[80:83], v[164:167], v[48:63]
  ds_read_b64_tr_b16 v[24:25], v2 offset:39424
  ds_read_b64_tr_b16 v[26:27], v2 offset:40448
  v_mfma_f32_32x32x16_bf16 v[64:79], v[84:87], v[164:167], v[64:79]
  ds_read_b64_tr_b16 v[28:29], v3 offset:38912
  ds_read_b64_tr_b16 v[30:31], v3 offset:39936
  s_waitcnt lgkmcnt(6) vmcnt(7)
  v_mfma_f32_32x32x16_bf16 v[32:47], v[88:91], v[168:171], v[32:47]
  s_barrier
  ds_read_b64_tr_b16 v[80:81], v2 offset:40960
  ds_read_b64_tr_b16 v[82:83], v2 offset:41984
  buffer_load_dwordx4 v[200:203], v1, s[24:27], s64 offen offset:2048 sc1
  v_mfma_f32_32x32x16_bf16 v[48:63], v[92:95], v[168:171], v[48:63]
  ds_read_b64_tr_b16 v[84:85], v2 offset:41472
  ds_read_b64_tr_b16 v[86:87], v2 offset:42496
  v_mfma_f32_32x32x16_bf16 v[64:79], v[16:19], v[168:171], v[64:79]
  ds_read_b64_tr_b16 v[88:89], v3 offset:40960
  ds_read_b64_tr_b16 v[90:91], v3 offset:41984
  s_waitcnt lgkmcnt(6) vmcnt(7)
  v_mfma_f32_32x32x16_bf16 v[32:47], v[20:23], v[172:175], v[32:47]
  ds_read_b64_tr_b16 v[92:93], v2 offset:43008
  ds_read_b64_tr_b16 v[94:95], v2 offset:44032
  buffer_load_dwordx4 v[204:207], v1, s[24:27], s64 offen offset:3072 sc1
  v_mfma_f32_32x32x16_bf16 v[48:63], v[24:27], v[172:175], v[48:63]
  ds_read_b64_tr_b16 v[16:17], v2 offset:43520
  ds_read_b64_tr_b16 v[18:19], v2 offset:44544
  v_mfma_f32_32x32x16_bf16 v[64:79], v[28:31], v[172:175], v[64:79]
  ds_read_b64_tr_b16 v[20:21], v3 offset:43008
  ds_read_b64_tr_b16 v[22:23], v3 offset:44032
  s_waitcnt lgkmcnt(6) vmcnt(7)
  v_mfma_f32_32x32x16_bf16 v[32:47], v[80:83], v[176:179], v[32:47]
  ds_read_b64_tr_b16 v[24:25], v2 offset:45056
  ds_read_b64_tr_b16 v[26:27], v2 offset:46080
  s_add_u32 s64, s64, 4096
  buffer_load_dwordx4 v[208:211], v1, s[24:27], s64 offen  sc1
  v_mfma_f32_32x32x16_bf16 v[48:63], v[84:87], v[176:179], v[48:63]
  ds_read_b64_tr_b16 v[28:29], v2 offset:45568
  ds_read_b64_tr_b16 v[30:31], v2 offset:46592
  v_mfma_f32_32x32x16_bf16 v[64:79], v[88:91], v[176:179], v[64:79]
  ds_read_b64_tr_b16 v[80:81], v3 offset:45056
  ds_read_b64_tr_b16 v[82:83], v3 offset:46080
  s_waitcnt lgkmcnt(6) vmcnt(7)
  v_mfma_f32_32x32x16_bf16 v[32:47], v[92:95], v[180:183], v[32:47]
  ds_read_b64_tr_b16 v[84:85], v2 offset:47104
  ds_read_b64_tr_b16 v[86:87], v2 offset:48128
  buffer_load_dwordx4 v[212:215], v1, s[24:27], s64 offen offset:1024 sc1
  v_mfma_f32_32x32x16_bf16 v[48:63], v[16:19], v[180:183], v[48:63]
  ds_read_b64_tr_b16 v[88:89], v2 offset:47616
  ds_read_b64_tr_b16 v[90:91], v2 offset:48640
  v_mfma_f32_32x32x16_bf16 v[64:79], v[20:23], v[180:183], v[64:79]
  ds_read_b64_tr_b16 v[92:93], v3 offset:47104
  ds_read_b64_tr_b16 v[94:95], v3 offset:48128
  s_waitcnt lgkmcnt(6) vmcnt(7)
  v_mfma_f32_32x32x16_bf16 v[32:47], v[24:27], v[184:187], v[32:47]
  ds_read_b64_tr_b16 v[16:17], v2 offset:49152
  ds_read_b64_tr_b16 v[18:19], v2 offset:50176
  buffer_load_dwordx4 v[216:219], v1, s[24:27], s64 offen offset:2048 sc1
  v_mfma_f32_32x32x16_bf16 v[48:63], v[28:31], v[184:187], v[48:63]
  ds_read_b64_tr_b16 v[20:21], v2 offset:49664
  ds_read_b64_tr_b16 v[22:23], v2 offset:50688
  v_mfma_f32_32x32x16_bf16 v[64:79], v[80:83], v[184:187], v[64:79]
  ds_read_b64_tr_b16 v[24:25], v3 offset:49152
  ds_read_b64_tr_b16 v[26:27], v3 offset:50176
  s_waitcnt lgkmcnt(6) vmcnt(7)
  v_mfma_f32_32x32x16_bf16 v[32:47], v[84:87], v[188:191], v[32:47]
  ds_read_b64_tr_b16 v[28:29], v2 offset:51200
  ds_read_b64_tr_b16 v[30:31], v2 offset:52224
  buffer_load_dwordx4 v[220:223], v1, s[24:27], s64 offen offset:3072 sc1
  v_mfma_f32_32x32x16_bf16 v[48:63], v[88:91], v[188:191], v[48:63]
  ds_read_b64_tr_b16 v[80:81], v2 offset:51712
  ds_read_b64_tr_b16 v[82:83], v2 offset:52736
  v_mfma_f32_32x32x16_bf16 v[64:79], v[92:95], v[188:191], v[64:79]
  ds_read_b64_tr_b16 v[84:85], v3 offset:51200
  ds_read_b64_tr_b16 v[86:87], v3 offset:52224
  s_waitcnt lgkmcnt(6) vmcnt(7)
  v_mfma_f32_32x32x16_bf16 v[32:47], v[16:19], v[192:195], v[32:47]
  ds_read_b64_tr_b16 v[88:89], v2 offset:53248
  ds_read_b64_tr_b16 v[90:91], v2 offset:54272
  v_lshrrev_b32 v11, 7, v1
  v_mul_u32_u24 v11, 2048, v11
  s_mov_b32 m0, 131072
  v_mfma_f32_32x32x16_bf16 v[48:63], v[20:23], v[192:195], v[48:63]
  ds_read_b64_tr_b16 v[92:93], v2 offset:53760
  ds_read_b64_tr_b16 v[94:95], v2 offset:54784
  v_mfma_f32_32x32x16_bf16 v[64:79], v[24:27], v[192:195], v[64:79]
  ds_read_b64_tr_b16 v[16:17], v3 offset:53248
  ds_read_b64_tr_b16 v[18:19], v3 offset:54272
  s_waitcnt lgkmcnt(6) vmcnt(6)
  v_mfma_f32_32x32x16_bf16 v[32:47], v[28:31], v[196:199], v[32:47]
  ds_read_b64_tr_b16 v[20:21], v2 offset:55296
  ds_read_b64_tr_b16 v[22:23], v2 offset:56320
  v_lshl_add_u32 v11, v1, 3, v11
  s_lshr_b32 s60, s81, 1
  s_add_u32 s60, s60, s81
  v_mfma_f32_32x32x16_bf16 v[48:63], v[80:83], v[196:199], v[48:63]
  ds_read_b64_tr_b16 v[24:25], v2 offset:55808
  ds_read_b64_tr_b16 v[26:27], v2 offset:56832
  v_mfma_f32_32x32x16_bf16 v[64:79], v[84:87], v[196:199], v[64:79]
  ds_read_b64_tr_b16 v[28:29], v3 offset:55296
  ds_read_b64_tr_b16 v[30:31], v3 offset:56320
  s_waitcnt lgkmcnt(6) vmcnt(5)
  v_mfma_f32_32x32x16_bf16 v[32:47], v[88:91], v[200:203], v[32:47]
  ds_read_b64_tr_b16 v[80:81], v2 offset:57344
  ds_read_b64_tr_b16 v[82:83], v2 offset:58368
  buffer_load_dword v11, s[8:11], s60 offen lds
  v_mov_b32 v11, 0
  v_mfma_f32_32x32x16_bf16 v[48:63], v[92:95], v[200:203], v[48:63]
  ds_read_b64_tr_b16 v[84:85], v2 offset:57856
  ds_read_b64_tr_b16 v[86:87], v2 offset:58880
  v_mfma_f32_32x32x16_bf16 v[64:79], v[16:19], v[200:203], v[64:79]
  ds_read_b64_tr_b16 v[88:89], v3 offset:57344
  ds_read_b64_tr_b16 v[90:91], v3 offset:58368
  s_waitcnt lgkmcnt(6) vmcnt(5)
  v_mfma_f32_32x32x16_bf16 v[32:47], v[20:23], v[204:207], v[32:47]
  ds_read_b64_tr_b16 v[92:93], v2 offset:59392
  ds_read_b64_tr_b16 v[94:95], v2 offset:60416
  v_mfma_f32_32x32x16_bf16 v[48:63], v[24:27], v[204:207], v[48:63]
  ds_read_b64_tr_b16 v[16:17], v2 offset:59904
  ds_read_b64_tr_b16 v[18:19], v2 offset:60928
  v_mfma_f32_32x32x16_bf16 v[64:79], v[28:31], v[204:207], v[64:79]
  ds_read_b64_tr_b16 v[20:21], v3 offset:59392
  ds_read_b64_tr_b16 v[22:23], v3 offset:60416
  s_waitcnt lgkmcnt(6) vmcnt(4)
  v_mfma_f32_32x32x16_bf16 v[32:47], v[80:83], v[208:211], v[32:47]
  ds_read_b64_tr_b16 v[24:25], v2 offset:61440
  ds_read_b64_tr_b16 v[26:27], v2 offset:62464
  v_mfma_f32_32x32x16_bf16 v[48:63], v[84:87], v[208:211], v[48:63]
  ds_read_b64_tr_b16 v[28:29], v2 offset:61952
  ds_read_b64_tr_b16 v[30:31], v2 offset:62976
  v_mfma_f32_32x32x16_bf16 v[64:79], v[88:91], v[208:211], v[64:79]
  ds_read_b64_tr_b16 v[80:81], v3 offset:61440
  ds_read_b64_tr_b16 v[82:83], v3 offset:62464
  s_waitcnt lgkmcnt(6) vmcnt(3)
  v_mfma_f32_32x32x16_bf16 v[32:47], v[92:95], v[212:215], v[32:47]
  ds_read_b64_tr_b16 v[84:85], v2 offset:63488
  ds_read_b64_tr_b16 v[86:87], v2 offset:64512
  v_mfma_f32_32x32x16_bf16 v[48:63], v[16:19], v[212:215], v[48:63]
  ds_read_b64_tr_b16 v[88:89], v2 offset:64000
  ds_read_b64_tr_b16 v[90:91], v2 offset:65024
  v_mfma_f32_32x32x16_bf16 v[64:79], v[20:23], v[212:215], v[64:79]
  ds_read_b64_tr_b16 v[92:93], v3 offset:63488
  ds_read_b64_tr_b16 v[94:95], v3 offset:64512
  s_waitcnt lgkmcnt(6) vmcnt(2)
  v_mfma_f32_32x32x16_bf16 v[32:47], v[24:27], v[216:219], v[32:47]
  ds_read_b128 v[16:19], v7 offset:3072
  v_mfma_f32_32x32x16_bf16 v[48:63], v[28:31], v[216:219], v[48:63]
  ds_read_b128 v[20:23], v7 offset:4096
  v_mfma_f32_32x32x16_bf16 v[64:79], v[80:83], v[216:219], v[64:79]
  ds_read_b128 v[24:27], v7 offset:5120
  s_waitcnt lgkmcnt(3) vmcnt(1)
  v_mfma_f32_32x32x16_bf16 v[32:47], v[84:87], v[220:223], v[32:47]
  v_mfma_f32_32x32x16_bf16 v[48:63], v[88:91], v[220:223], v[48:63]
  v_mfma_f32_32x32x16_bf16 v[64:79], v[92:95], v[220:223], v[64:79]
  s_waitcnt lgkmcnt(0)
  v_mfma_f32_32x32x16_bf16 v[32:47], v[16:19], v[8:11], v[32:47]
  v_mfma_f32_32x32x16_bf16 v[48:63], v[20:23], v[8:11], v[48:63]
  v_mfma_f32_32x32x16_bf16 v[64:79], v[24:27], v[8:11], v[64:79]
  s_barrier
  s_mov_b32 m0, s94
  s_add_u32 s60, s95, 1024
  ds_read_b64_tr_b16 v[28:29], v3 offset:512
  ds_read_b64_tr_b16 v[30:31], v3 offset:1536
  ds_read_b64_tr_b16 v[16:17], v3 offset:2560
  ds_read_b64_tr_b16 v[18:19], v3 offset:3584
  ds_read_b64_tr_b16 v[20:21], v3 offset:4608
  ds_read_b64_tr_b16 v[22:23], v3 offset:5632
  ds_read_b64_tr_b16 v[24:25], v3 offset:6656
  ds_read_b64_tr_b16 v[26:27], v3 offset:7680
  s_waitcnt lgkmcnt(4)
  v_mfma_f32_32x32x16_bf16 v[80:95], v[28:31], v[96:99], 0
  ds_read_b64_tr_b16 v[96:97], v3 offset:8704
  ds_read_b64_tr_b16 v[98:99], v3 offset:9728
  buffer_load_dwordx4 v4, s[8:11], s60 offen nt lds
  s_add_u32 m0, m0, 1024
  s_add_u32 s60, s60, 49152
  v_mfma_f32_32x32x16_bf16 v[80:95], v[16:19], v[100:103], v[80:95]
  ds_read_b64_tr_b16 v[100:101], v3 offset:10752
  ds_read_b64_tr_b16 v[102:103], v3 offset:11776
  buffer_load_dwordx4 v4, s[8:11], s60 offen nt lds
  s_add_u32 m0, m0, 1024
  s_add_u32 s60, s60, 49152
  s_waitcnt lgkmcnt(4)
  v_mfma_f32_32x32x16_bf16 v[80:95], v[20:23], v[104:107], v[80:95]
  ds_read_b64_tr_b16 v[28:29], v3 offset:12800
  ds_read_b64_tr_b16 v[30:31], v3 offset:13824
  buffer_load_dwordx4 v4, s[8:11], s60 offen nt lds
  s_add_u32 m0, m0, 1024
  s_add_u32 s60, s60, 49152
  v_mfma_f32_32x32x16_bf16 v[80:95], v[24:27], v[108:111], v[80:95]
  ds_read_b64_tr_b16 v[16:17], v3 offset:14848
  ds_read_b64_tr_b16 v[18:19], v3 offset:15872
  buffer_load_dwordx4 v4, s[8:11], s60 offen nt lds
  s_add_u32 m0, m0, 1024
  s_add_u32 s60, s60, 49152
  s_waitcnt lgkmcnt(4)
  v_mfma_f32_32x32x16_bf16 v[80:95], v[96:99], v[112:115], v[80:95]
  ds_read_b64_tr_b16 v[20:21], v3 offset:16896
  ds_read_b64_tr_b16 v[22:23], v3 offset:17920
  buffer_load_dwordx4 v4, s[8:11], s60 offen nt lds
  s_add_u32 m0, m0, 1024
  s_add_u32 s60, s60, 49152
  v_mfma_f32_32x32x16_bf16 v[80:95], v[100:103], v[116:119], v[80:95]
  ds_read_b64_tr_b16 v[24:25], v3 offset:18944
  ds_read_b64_tr_b16 v[26:27], v3 offset:19968
  v_mul_f32 v104, v32, v32
  v_fma_f32 v104, v104, v14, v12
  v_mul_f32 v105, v33, v33
  v_mul_f32 v104, v104, v32
  s_waitcnt lgkmcnt(4)
  v_mfma_f32_32x32x16_bf16 v[80:95], v[28:31], v[120:123], v[80:95]
  ds_read_b64_tr_b16 v[96:97], v3 offset:20992
  ds_read_b64_tr_b16 v[98:99], v3 offset:22016
  v_fma_f32 v105, v105, v14, v12
  v_mul_f32 v106, v34, v34
  v_exp_f32 v104, v104
  v_mfma_f32_32x32x16_bf16 v[80:95], v[16:19], v[124:127], v[80:95]
  ds_read_b64_tr_b16 v[100:101], v3 offset:23040
  ds_read_b64_tr_b16 v[102:103], v3 offset:24064
  v_mul_f32 v105, v105, v33
  v_fma_f32 v106, v106, v14, v12
  v_mul_f32 v107, v35, v35
  s_waitcnt lgkmcnt(4)
  v_mfma_f32_32x32x16_bf16 v[80:95], v[20:23], v[128:131], v[80:95]
  ds_read_b64_tr_b16 v[28:29], v3 offset:25088
  ds_read_b64_tr_b16 v[30:31], v3 offset:26112
  buffer_load_dwordx4 v4, s[8:11], s60 offen nt lds
  s_add_u32 m0, m0, 1024
  s_add_u32 s60, s60, 49152
  v_mfma_f32_32x32x16_bf16 v[80:95], v[24:27], v[132:135], v[80:95]
  ds_read_b64_tr_b16 v[16:17], v3 offset:27136
  ds_read_b64_tr_b16 v[18:19], v3 offset:28160
  v_fma_f32 v104, v104, v15, v15
  v_exp_f32 v105, v105
  v_mul_f32 v106, v106, v34
  s_waitcnt lgkmcnt(4)
  v_mfma_f32_32x32x16_bf16 v[80:95], v[96:99], v[136:139], v[80:95]
  ds_read_b64_tr_b16 v[20:21], v3 offset:29184
  ds_read_b64_tr_b16 v[22:23], v3 offset:30208
  v_fma_f32 v107, v107, v14, v12
  v_rcp_f32 v104, v104
  v_mfma_f32_32x32x16_bf16 v[80:95], v[100:103], v[140:143], v[80:95]
  ds_read_b64_tr_b16 v[24:25], v3 offset:31232
  ds_read_b64_tr_b16 v[26:27], v3 offset:32256
  v_fma_f32 v105, v105, v15, v15
  v_exp_f32 v106, v106
  v_mul_f32 v107, v107, v35
  s_waitcnt lgkmcnt(4)
  v_mfma_f32_32x32x16_bf16 v[80:95], v[28:31], v[144:147], v[80:95]
  ds_read_b64_tr_b16 v[96:97], v3 offset:33280
  ds_read_b64_tr_b16 v[98:99], v3 offset:34304
  buffer_load_dwordx4 v4, s[8:11], s60 offen nt lds
  s_add_u32 m0, m0, 1024
  s_add_u32 s60, s60, 49152
  v_mfma_f32_32x32x16_bf16 v[80:95], v[16:19], v[148:151], v[80:95]
  ds_read_b64_tr_b16 v[100:101], v3 offset:35328
  ds_read_b64_tr_b16 v[102:103], v3 offset:36352
  v_mul_f32 v104, v104, v32
  v_rcp_f32 v105, v105
  v_fma_f32 v106, v106, v15, v15
  s_waitcnt lgkmcnt(4)
  v_mfma_f32_32x32x16_bf16 v[80:95], v[20:23], v[152:155], v[80:95]
  ds_read_b64_tr_b16 v[28:29], v3 offset:37376
  ds_read_b64_tr_b16 v[30:31], v3 offset:38400
  v_exp_f32 v107, v107
  v_mul_f32 v105, v105, v33
  v_mfma_f32_32x32x16_bf16 v[80:95], v[24:27], v[156:159], v[80:95]
  ds_read_b64_tr_b16 v[16:17], v3 offset:39424
  ds_read_b64_tr_b16 v[18:19], v3 offset:40448
  v_rcp_f32 v106, v106
  v_fma_f32 v107, v107, v15, v15
  v_mul_f32 v106, v106, v34
  s_waitcnt lgkmcnt(4)
  v_mfma_f32_32x32x16_bf16 v[80:95], v[96:99], v[160:163], v[80:95]
  ds_read_b64_tr_b16 v[20:21], v3 offset:41472
  ds_read_b64_tr_b16 v[22:23], v3 offset:42496
  buffer_load_dwordx4 v4, s[8:11], s60 offen nt lds
  s_add_u32 m0, m0, 1024
  s_add_u32 s60, s60, 49152
  s_add_u32 m0, s94, 32768
  s_add_u32 s60, s95, 2048
  v_mfma_f32_32x32x16_bf16 v[80:95], v[100:103], v[164:167], v[80:95]
  ds_read_b64_tr_b16 v[24:25], v3 offset:43520
  ds_read_b64_tr_b16 v[26:27], v3 offset:44544
  v_rcp_f32 v107, v107
  s_nop 0
  v_mul_f32 v107, v107, v35
  v_cvt_pk_bf16_f32 v32, v104, v105
  s_waitcnt lgkmcnt(4)
  v_mfma_f32_32x32x16_bf16 v[80:95], v[28:31], v[168:171], v[80:95]
  ds_read_b64_tr_b16 v[96:97], v3 offset:45568
  ds_read_b64_tr_b16 v[98:99], v3 offset:46592
  v_cvt_pk_bf16_f32 v33, v106, v107
  v_mul_f32 v108, v36, v36
  v_fma_f32 v108, v108, v14, v12
  v_mfma_f32_32x32x16_bf16 v[80:95], v[16:19], v[172:175], v[80:95]
  ds_read_b64_tr_b16 v[100:101], v3 offset:47616
  ds_read_b64_tr_b16 v[102:103], v3 offset:48640
  v_mul_f32 v109, v37, v37
  v_mul_f32 v108, v108, v36
  v_fma_f32 v109, v109, v14, v12
  v_mul_f32 v110, v38, v38
  s_waitcnt lgkmcnt(4)
  v_mfma_f32_32x32x16_bf16 v[80:95], v[20:23], v[176:179], v[80:95]
  ds_read_b64_tr_b16 v[28:29], v3 offset:49664
  ds_read_b64_tr_b16 v[30:31], v3 offset:50688
  buffer_load_dwordx4 v4, s[8:11], s60 offen nt lds
  s_add_u32 m0, m0, 1024
  s_add_u32 s60, s60, 49152
  v_mfma_f32_32x32x16_bf16 v[80:95], v[24:27], v[180:183], v[80:95]
  ds_read_b64_tr_b16 v[16:17], v3 offset:51712
  ds_read_b64_tr_b16 v[18:19], v3 offset:52736
  v_exp_f32 v108, v108
  v_mul_f32 v109, v109, v37
  v_fma_f32 v110, v110, v14, v12
  s_waitcnt lgkmcnt(4)
  v_mfma_f32_32x32x16_bf16 v[80:95], v[96:99], v[184:187], v[80:95]
  ds_read_b64_tr_b16 v[20:21], v3 offset:53760
  ds_read_b64_tr_b16 v[22:23], v3 offset:54784
  v_mul_f32 v111, v39, v39
  v_fma_f32 v108, v108, v15, v15
  v_exp_f32 v109, v109
  v_mfma_f32_32x32x16_bf16 v[80:95], v[100:103], v[188:191], v[80:95]
  ds_read_b64_tr_b16 v[24:25], v3 offset:55808
  ds_read_b64_tr_b16 v[26:27], v3 offset:56832
  v_mul_f32 v110, v110, v38
  v_fma_f32 v111, v111, v14, v12
  v_rcp_f32 v108, v108
  s_waitcnt lgkmcnt(4)
  v_mfma_f32_32x32x16_bf16 v[80:95], v[28:31], v[192:195], v[80:95]
  ds_read_b64_tr_b16 v[96:97], v3 offset:57856
  ds_read_b64_tr_b16 v[98:99], v3 offset:58880
  buffer_load_dwordx4 v4, s[8:11], s60 offen nt lds
  s_add_u32 m0, m0, 1024
  s_add_u32 s60, s60, 49152
  v_mfma_f32_32x32x16_bf16 v[80:95], v[16:19], v[196:199], v[80:95]
  ds_read_b64_tr_b16 v[100:101], v3 offset:59904
  ds_read_b64_tr_b16 v[102:103], v3 offset:60928
  v_fma_f32 v109, v109, v15, v15
  v_exp_f32 v110, v110
  s_waitcnt lgkmcnt(4)
  v_mfma_f32_32x32x16_bf16 v[80:95], v[20:23], v[200:203], v[80:95]
  ds_read_b64_tr_b16 v[28:29], v3 offset:61952
  ds_read_b64_tr_b16 v[30:31], v3 offset:62976
  v_mul_f32 v111, v111, v39
  v_mul_f32 v108, v108, v36
  v_rcp_f32 v109, v109
  v_mfma_f32_32x32x16_bf16 v[80:95], v[24:27], v[204:207], v[80:95]
  ds_read_b64_tr_b16 v[16:17], v3 offset:64000
  ds_read_b64_tr_b16 v[18:19], v3 offset:65024
  v_fma_f32 v110, v110, v15, v15
  v_exp_f32 v111, v111
  s_waitcnt lgkmcnt(4)
  v_mfma_f32_32x32x16_bf16 v[80:95], v[96:99], v[208:211], v[80:95]
  ds_read_b128 v[20:23], v7 offset:6144
  buffer_load_dwordx4 v4, s[8:11], s60 offen nt lds
  s_add_u32 m0, m0, 1024
  s_add_u32 s60, s60, 49152
  v_mfma_f32_32x32x16_bf16 v[80:95], v[100:103], v[212:215], v[80:95]
  v_mul_f32 v109, v109, v37
  v_rcp_f32 v110, v110
  v_fma_f32 v111, v111, v15, v15
  s_waitcnt lgkmcnt(1)
  v_mfma_f32_32x32x16_bf16 v[80:95], v[28:31], v[216:219], v[80:95]
  v_mul_f32 v110, v110, v38
  v_rcp_f32 v111, v111
  v_mfma_f32_32x32x16_bf16 v[80:95], v[16:19], v[220:223], v[80:95]
  v_mul_f32 v111, v111, v39
  v_cvt_pk_bf16_f32 v34, v108, v109
  v_cvt_pk_bf16_f32 v35, v110, v111
  buffer_store_dwordx4 v[32:35], v1, s[24:27], s85 offen offset:0
  s_waitcnt lgkmcnt(0)
  v_mfma_f32_32x32x16_bf16 v[80:95], v[20:23], v[8:11], v[80:95]
  buffer_load_dwordx4 v4, s[8:11], s60 offen nt lds
  s_add_u32 m0, m0, 1024
  s_add_u32 s60, s60, 49152
  buffer_load_dwordx4 v4, s[8:11], s60 offen nt lds
  s_add_u32 m0, m0, 1024
  s_add_u32 s60, s60, 49152
  v_pk_mul_f32 v[104:105], v[40:41], v[40:41]
  v_pk_mul_f32 v[106:107], v[42:43], v[42:43]
  v_pk_fma_f32 v[104:105], v[104:105], v[14:15], v[12:13] op_sel_hi:[1,0,0]
  v_pk_fma_f32 v[106:107], v[106:107], v[14:15], v[12:13] op_sel_hi:[1,0,0]
  v_pk_mul_f32 v[104:105], v[104:105], v[40:41]
  v_pk_mul_f32 v[106:107], v[106:107], v[42:43]
  v_exp_f32 v104, v104
  v_exp_f32 v105, v105
  v_exp_f32 v106, v106
  v_exp_f32 v107, v107
  v_pk_fma_f32 v[104:105], v[104:105], v[14:15], v[14:15] op_sel:[0,1,1] op_sel_hi:[1,1,1]
  v_pk_fma_f32 v[106:107], v[106:107], v[14:15], v[14:15] op_sel:[0,1,1] op_sel_hi:[1,1,1]
  v_rcp_f32 v104, v104
  v_rcp_f32 v105, v105
  v_rcp_f32 v106, v106
  v_rcp_f32 v107, v107
  v_pk_mul_f32 v[104:105], v[104:105], v[40:41]
  v_pk_mul_f32 v[106:107], v[106:107], v[42:43]
  v_cvt_pk_bf16_f32 v36, v104, v105
  v_cvt_pk_bf16_f32 v37, v106, v107
  buffer_load_dwordx4 v4, s[8:11], s60 offen nt lds
  s_add_u32 m0, m0, 1024
  s_add_u32 s60, s60, 49152
  v_pk_mul_f32 v[108:109], v[44:45], v[44:45]
  v_pk_mul_f32 v[110:111], v[46:47], v[46:47]
  v_pk_fma_f32 v[108:109], v[108:109], v[14:15], v[12:13] op_sel_hi:[1,0,0]
  v_pk_fma_f32 v[110:111], v[110:111], v[14:15], v[12:13] op_sel_hi:[1,0,0]
  v_pk_mul_f32 v[108:109], v[108:109], v[44:45]
  v_pk_mul_f32 v[110:111], v[110:111], v[46:47]
  v_exp_f32 v108, v108
  v_exp_f32 v109, v109
  v_exp_f32 v110, v110
  v_exp_f32 v111, v111
  v_pk_fma_f32 v[108:109], v[108:109], v[14:15], v[14:15] op_sel:[0,1,1] op_sel_hi:[1,1,1]
  v_pk_fma_f32 v[110:111], v[110:111], v[14:15], v[14:15] op_sel:[0,1,1] op_sel_hi:[1,1,1]
  v_rcp_f32 v108, v108
  v_rcp_f32 v109, v109
  v_rcp_f32 v110, v110
  v_rcp_f32 v111, v111
  v_pk_mul_f32 v[108:109], v[108:109], v[44:45]
  v_pk_mul_f32 v[110:111], v[110:111], v[46:47]
  v_cvt_pk_bf16_f32 v38, v108, v109
  v_cvt_pk_bf16_f32 v39, v110, v111
  buffer_store_dwordx4 v[36:39], v1, s[24:27], s85 offen offset:1024
  buffer_load_dwordx4 v4, s[8:11], s60 offen nt lds
  s_add_u32 m0, m0, 1024
  s_add_u32 s60, s60, 49152
  v_pk_mul_f32 v[104:105], v[48:49], v[48:49]
  v_pk_mul_f32 v[106:107], v[50:51], v[50:51]
  v_pk_fma_f32 v[104:105], v[104:105], v[14:15], v[12:13] op_sel_hi:[1,0,0]
  v_pk_fma_f32 v[106:107], v[106:107], v[14:15], v[12:13] op_sel_hi:[1,0,0]
  v_pk_mul_f32 v[104:105], v[104:105], v[48:49]
  v_pk_mul_f32 v[106:107], v[106:107], v[50:51]
  v_exp_f32 v104, v104
  v_exp_f32 v105, v105
  v_exp_f32 v106, v106
  v_exp_f32 v107, v107
  v_pk_fma_f32 v[104:105], v[104:105], v[14:15], v[14:15] op_sel:[0,1,1] op_sel_hi:[1,1,1]
  v_pk_fma_f32 v[106:107], v[106:107], v[14:15], v[14:15] op_sel:[0,1,1] op_sel_hi:[1,1,1]
  v_rcp_f32 v104, v104
  v_rcp_f32 v105, v105
  v_rcp_f32 v106, v106
  v_rcp_f32 v107, v107
  v_pk_mul_f32 v[104:105], v[104:105], v[48:49]
  v_pk_mul_f32 v[106:107], v[106:107], v[50:51]
  v_cvt_pk_bf16_f32 v48, v104, v105
  v_cvt_pk_bf16_f32 v49, v106, v107
  buffer_load_dwordx4 v4, s[8:11], s60 offen nt lds
  s_add_u32 m0, m0, 1024
  s_add_u32 s60, s60, 49152
  v_pk_mul_f32 v[108:109], v[52:53], v[52:53]
  v_pk_mul_f32 v[110:111], v[54:55], v[54:55]
  v_pk_fma_f32 v[108:109], v[108:109], v[14:15], v[12:13] op_sel_hi:[1,0,0]
  v_pk_fma_f32 v[110:111], v[110:111], v[14:15], v[12:13] op_sel_hi:[1,0,0]
  v_pk_mul_f32 v[108:109], v[108:109], v[52:53]
  v_pk_mul_f32 v[110:111], v[110:111], v[54:55]
  v_exp_f32 v108, v108
  v_exp_f32 v109, v109
  v_exp_f32 v110, v110
  v_exp_f32 v111, v111
  v_pk_fma_f32 v[108:109], v[108:109], v[14:15], v[14:15] op_sel:[0,1,1] op_sel_hi:[1,1,1]
  v_pk_fma_f32 v[110:111], v[110:111], v[14:15], v[14:15] op_sel:[0,1,1] op_sel_hi:[1,1,1]
  v_rcp_f32 v108, v108
  v_rcp_f32 v109, v109
  v_rcp_f32 v110, v110
  v_rcp_f32 v111, v111
  v_pk_mul_f32 v[108:109], v[108:109], v[52:53]
  v_pk_mul_f32 v[110:111], v[110:111], v[54:55]
  v_cvt_pk_bf16_f32 v50, v108, v109
  v_cvt_pk_bf16_f32 v51, v110, v111
  buffer_store_dwordx4 v[48:51], v1, s[24:27], s85 offen offset:2048
  v_pk_mul_f32 v[104:105], v[56:57], v[56:57]
  v_pk_mul_f32 v[106:107], v[58:59], v[58:59]
  v_pk_fma_f32 v[104:105], v[104:105], v[14:15], v[12:13] op_sel_hi:[1,0,0]
  v_pk_fma_f32 v[106:107], v[106:107], v[14:15], v[12:13] op_sel_hi:[1,0,0]
  v_pk_mul_f32 v[104:105], v[104:105], v[56:57]
  v_pk_mul_f32 v[106:107], v[106:107], v[58:59]
  v_exp_f32 v104, v104
  v_exp_f32 v105, v105
  v_exp_f32 v106, v106
  v_exp_f32 v107, v107
  v_pk_fma_f32 v[104:105], v[104:105], v[14:15], v[14:15] op_sel:[0,1,1] op_sel_hi:[1,1,1]
  v_pk_fma_f32 v[106:107], v[106:107], v[14:15], v[14:15] op_sel:[0,1,1] op_sel_hi:[1,1,1]
  v_rcp_f32 v104, v104
  v_rcp_f32 v105, v105
  v_rcp_f32 v106, v106
  v_rcp_f32 v107, v107
  v_pk_mul_f32 v[104:105], v[104:105], v[56:57]
  v_pk_mul_f32 v[106:107], v[106:107], v[58:59]
  v_cvt_pk_bf16_f32 v52, v104, v105
  v_cvt_pk_bf16_f32 v53, v106, v107
  v_pk_mul_f32 v[108:109], v[60:61], v[60:61]
  v_pk_mul_f32 v[110:111], v[62:63], v[62:63]
  v_pk_fma_f32 v[108:109], v[108:109], v[14:15], v[12:13] op_sel_hi:[1,0,0]
  v_pk_fma_f32 v[110:111], v[110:111], v[14:15], v[12:13] op_sel_hi:[1,0,0]
  v_pk_mul_f32 v[108:109], v[108:109], v[60:61]
  v_pk_mul_f32 v[110:111], v[110:111], v[62:63]
  v_exp_f32 v108, v108
  v_exp_f32 v109, v109
  v_exp_f32 v110, v110
  v_exp_f32 v111, v111
  v_pk_fma_f32 v[108:109], v[108:109], v[14:15], v[14:15] op_sel:[0,1,1] op_sel_hi:[1,1,1]
  v_pk_fma_f32 v[110:111], v[110:111], v[14:15], v[14:15] op_sel:[0,1,1] op_sel_hi:[1,1,1]
  v_rcp_f32 v108, v108
  v_rcp_f32 v109, v109
  v_rcp_f32 v110, v110
  v_rcp_f32 v111, v111
  v_pk_mul_f32 v[108:109], v[108:109], v[60:61]
  v_pk_mul_f32 v[110:111], v[110:111], v[62:63]
  v_cvt_pk_bf16_f32 v54, v108, v109
  v_cvt_pk_bf16_f32 v55, v110, v111
  buffer_store_dwordx4 v[52:55], v1, s[24:27], s85 offen offset:3072
  v_pk_mul_f32 v[104:105], v[64:65], v[64:65]
  v_pk_mul_f32 v[106:107], v[66:67], v[66:67]
  v_pk_fma_f32 v[104:105], v[104:105], v[14:15], v[12:13] op_sel_hi:[1,0,0]
  v_pk_fma_f32 v[106:107], v[106:107], v[14:15], v[12:13] op_sel_hi:[1,0,0]
  v_pk_mul_f32 v[104:105], v[104:105], v[64:65]
  v_pk_mul_f32 v[106:107], v[106:107], v[66:67]
  v_exp_f32 v104, v104
  v_exp_f32 v105, v105
  v_exp_f32 v106, v106
  v_exp_f32 v107, v107
  v_pk_fma_f32 v[104:105], v[104:105], v[14:15], v[14:15] op_sel:[0,1,1] op_sel_hi:[1,1,1]
  v_pk_fma_f32 v[106:107], v[106:107], v[14:15], v[14:15] op_sel:[0,1,1] op_sel_hi:[1,1,1]
  v_rcp_f32 v104, v104
  v_rcp_f32 v105, v105
  v_rcp_f32 v106, v106
  v_rcp_f32 v107, v107
  v_pk_mul_f32 v[104:105], v[104:105], v[64:65]
  v_pk_mul_f32 v[106:107], v[106:107], v[66:67]
  v_cvt_pk_bf16_f32 v64, v104, v105
  v_cvt_pk_bf16_f32 v65, v106, v107
  v_pk_mul_f32 v[108:109], v[68:69], v[68:69]
  v_pk_mul_f32 v[110:111], v[70:71], v[70:71]
  v_pk_fma_f32 v[108:109], v[108:109], v[14:15], v[12:13] op_sel_hi:[1,0,0]
  v_pk_fma_f32 v[110:111], v[110:111], v[14:15], v[12:13] op_sel_hi:[1,0,0]
  v_pk_mul_f32 v[108:109], v[108:109], v[68:69]
  v_pk_mul_f32 v[110:111], v[110:111], v[70:71]
  v_exp_f32 v108, v108
  v_exp_f32 v109, v109
  v_exp_f32 v110, v110
  v_exp_f32 v111, v111
  v_pk_fma_f32 v[108:109], v[108:109], v[14:15], v[14:15] op_sel:[0,1,1] op_sel_hi:[1,1,1]
  v_pk_fma_f32 v[110:111], v[110:111], v[14:15], v[14:15] op_sel:[0,1,1] op_sel_hi:[1,1,1]
  v_rcp_f32 v108, v108
  v_rcp_f32 v109, v109
  v_rcp_f32 v110, v110
  v_rcp_f32 v111, v111
  v_pk_mul_f32 v[108:109], v[108:109], v[68:69]
  v_pk_mul_f32 v[110:111], v[110:111], v[70:71]
  v_cvt_pk_bf16_f32 v66, v108, v109
  v_cvt_pk_bf16_f32 v67, v110, v111
  buffer_store_dwordx4 v[64:67], v1, s[24:27], s80 offen offset:0
  v_pk_mul_f32 v[104:105], v[72:73], v[72:73]
  v_pk_mul_f32 v[106:107], v[74:75], v[74:75]
  v_pk_fma_f32 v[104:105], v[104:105], v[14:15], v[12:13] op_sel_hi:[1,0,0]
  v_pk_fma_f32 v[106:107], v[106:107], v[14:15], v[12:13] op_sel_hi:[1,0,0]
  v_pk_mul_f32 v[104:105], v[104:105], v[72:73]
  v_pk_mul_f32 v[106:107], v[106:107], v[74:75]
  v_exp_f32 v104, v104
  v_exp_f32 v105, v105
  v_exp_f32 v106, v106
  v_exp_f32 v107, v107
  v_pk_fma_f32 v[104:105], v[104:105], v[14:15], v[14:15] op_sel:[0,1,1] op_sel_hi:[1,1,1]
  v_pk_fma_f32 v[106:107], v[106:107], v[14:15], v[14:15] op_sel:[0,1,1] op_sel_hi:[1,1,1]
  v_rcp_f32 v104, v104
  v_rcp_f32 v105, v105
  v_rcp_f32 v106, v106
  v_rcp_f32 v107, v107
  v_pk_mul_f32 v[104:105], v[104:105], v[72:73]
  v_pk_mul_f32 v[106:107], v[106:107], v[74:75]
  v_cvt_pk_bf16_f32 v68, v104, v105
  v_cvt_pk_bf16_f32 v69, v106, v107
  v_pk_mul_f32 v[108:109], v[76:77], v[76:77]
  v_pk_mul_f32 v[110:111], v[78:79], v[78:79]
  v_pk_fma_f32 v[108:109], v[108:109], v[14:15], v[12:13] op_sel_hi:[1,0,0]
  v_pk_fma_f32 v[110:111], v[110:111], v[14:15], v[12:13] op_sel_hi:[1,0,0]
  v_pk_mul_f32 v[108:109], v[108:109], v[76:77]
  v_pk_mul_f32 v[110:111], v[110:111], v[78:79]
  v_exp_f32 v108, v108
  v_exp_f32 v109, v109
  v_exp_f32 v110, v110
  v_exp_f32 v111, v111
  v_pk_fma_f32 v[108:109], v[108:109], v[14:15], v[14:15] op_sel:[0,1,1] op_sel_hi:[1,1,1]
  v_pk_fma_f32 v[110:111], v[110:111], v[14:15], v[14:15] op_sel:[0,1,1] op_sel_hi:[1,1,1]
  v_rcp_f32 v108, v108
  v_rcp_f32 v109, v109
  v_rcp_f32 v110, v110
  v_rcp_f32 v111, v111
  v_pk_mul_f32 v[108:109], v[108:109], v[76:77]
  v_pk_mul_f32 v[110:111], v[110:111], v[78:79]
  v_cvt_pk_bf16_f32 v70, v108, v109
  v_cvt_pk_bf16_f32 v71, v110, v111
  buffer_store_dwordx4 v[68:71], v1, s[24:27], s80 offen offset:1024
  v_pk_mul_f32 v[104:105], v[80:81], v[80:81]
  v_pk_mul_f32 v[106:107], v[82:83], v[82:83]
  v_pk_fma_f32 v[104:105], v[104:105], v[14:15], v[12:13] op_sel_hi:[1,0,0]
  v_pk_fma_f32 v[106:107], v[106:107], v[14:15], v[12:13] op_sel_hi:[1,0,0]
  v_pk_mul_f32 v[104:105], v[104:105], v[80:81]
  v_pk_mul_f32 v[106:107], v[106:107], v[82:83]
  v_exp_f32 v104, v104
  v_exp_f32 v105, v105
  v_exp_f32 v106, v106
  v_exp_f32 v107, v107
  v_pk_fma_f32 v[104:105], v[104:105], v[14:15], v[14:15] op_sel:[0,1,1] op_sel_hi:[1,1,1]
  v_pk_fma_f32 v[106:107], v[106:107], v[14:15], v[14:15] op_sel:[0,1,1] op_sel_hi:[1,1,1]
  v_rcp_f32 v104, v104
  v_rcp_f32 v105, v105
  v_rcp_f32 v106, v106
  v_rcp_f32 v107, v107
  v_pk_mul_f32 v[104:105], v[104:105], v[80:81]
  v_pk_mul_f32 v[106:107], v[106:107], v[82:83]
  v_cvt_pk_bf16_f32 v80, v104, v105
  v_cvt_pk_bf16_f32 v81, v106, v107
  v_pk_mul_f32 v[108:109], v[84:85], v[84:85]
  v_pk_mul_f32 v[110:111], v[86:87], v[86:87]
  v_pk_fma_f32 v[108:109], v[108:109], v[14:15], v[12:13] op_sel_hi:[1,0,0]
  v_pk_fma_f32 v[110:111], v[110:111], v[14:15], v[12:13] op_sel_hi:[1,0,0]
  v_pk_mul_f32 v[108:109], v[108:109], v[84:85]
  v_pk_mul_f32 v[110:111], v[110:111], v[86:87]
  v_exp_f32 v108, v108
  v_exp_f32 v109, v109
  v_exp_f32 v110, v110
  v_exp_f32 v111, v111
  v_pk_fma_f32 v[108:109], v[108:109], v[14:15], v[14:15] op_sel:[0,1,1] op_sel_hi:[1,1,1]
  v_pk_fma_f32 v[110:111], v[110:111], v[14:15], v[14:15] op_sel:[0,1,1] op_sel_hi:[1,1,1]
  v_rcp_f32 v108, v108
  v_rcp_f32 v109, v109
  v_rcp_f32 v110, v110
  v_rcp_f32 v111, v111
  v_pk_mul_f32 v[108:109], v[108:109], v[84:85]
  v_pk_mul_f32 v[110:111], v[110:111], v[86:87]
  v_cvt_pk_bf16_f32 v82, v108, v109
  v_cvt_pk_bf16_f32 v83, v110, v111
  buffer_store_dwordx4 v[80:83], v1, s[24:27], s80 offen offset:2048
  v_pk_mul_f32 v[104:105], v[88:89], v[88:89]
  v_pk_mul_f32 v[106:107], v[90:91], v[90:91]
  v_pk_fma_f32 v[104:105], v[104:105], v[14:15], v[12:13] op_sel_hi:[1,0,0]
  v_pk_fma_f32 v[106:107], v[106:107], v[14:15], v[12:13] op_sel_hi:[1,0,0]
  v_pk_mul_f32 v[104:105], v[104:105], v[88:89]
  v_pk_mul_f32 v[106:107], v[106:107], v[90:91]
  v_exp_f32 v104, v104
  v_exp_f32 v105, v105
  v_exp_f32 v106, v106
  v_exp_f32 v107, v107
  v_pk_fma_f32 v[104:105], v[104:105], v[14:15], v[14:15] op_sel:[0,1,1] op_sel_hi:[1,1,1]
  v_pk_fma_f32 v[106:107], v[106:107], v[14:15], v[14:15] op_sel:[0,1,1] op_sel_hi:[1,1,1]
  v_rcp_f32 v104, v104
  v_rcp_f32 v105, v105
  v_rcp_f32 v106, v106
  v_rcp_f32 v107, v107
  v_pk_mul_f32 v[104:105], v[104:105], v[88:89]
  v_pk_mul_f32 v[106:107], v[106:107], v[90:91]
  v_cvt_pk_bf16_f32 v84, v104, v105
  v_cvt_pk_bf16_f32 v85, v106, v107
  v_pk_mul_f32 v[108:109], v[92:93], v[92:93]
  v_pk_mul_f32 v[110:111], v[94:95], v[94:95]
  v_pk_fma_f32 v[108:109], v[108:109], v[14:15], v[12:13] op_sel_hi:[1,0,0]
  v_pk_fma_f32 v[110:111], v[110:111], v[14:15], v[12:13] op_sel_hi:[1,0,0]
  v_pk_mul_f32 v[108:109], v[108:109], v[92:93]
  v_pk_mul_f32 v[110:111], v[110:111], v[94:95]
  v_exp_f32 v108, v108
  v_exp_f32 v109, v109
  v_exp_f32 v110, v110
  v_exp_f32 v111, v111
  v_pk_fma_f32 v[108:109], v[108:109], v[14:15], v[14:15] op_sel:[0,1,1] op_sel_hi:[1,1,1]
  v_pk_fma_f32 v[110:111], v[110:111], v[14:15], v[14:15] op_sel:[0,1,1] op_sel_hi:[1,1,1]
  v_rcp_f32 v108, v108
  v_rcp_f32 v109, v109
  v_rcp_f32 v110, v110
  v_rcp_f32 v111, v111
  v_pk_mul_f32 v[108:109], v[108:109], v[92:93]
  v_pk_mul_f32 v[110:111], v[110:111], v[94:95]
  v_cvt_pk_bf16_f32 v86, v108, v109
  v_cvt_pk_bf16_f32 v87, v110, v111
  buffer_store_dwordx4 v[84:87], v1, s[24:27], s80 offen offset:3072
  s_add_u32 s60, s83, 512
  s_cmp_lg_u32 s52, 0
  s_waitcnt vmcnt(0)
  s_mov_b64 exec, 1
  s_cbranch_scc1 SL21
  buffer_store_dword v3, off, s[24:27], s60
DN22:
  s_mov_b64 exec, -1
  s_barrier
P4:
  s_lshl_b32 s60, s87, 7
  s_and_b32 s61, s50, 1
  s_lshl_b32 s61, s61, 6
  s_add_u32 s60, s60, s61
  v_lshrrev_b32 v25, 6, v1
  v_and_b32 v25, 8, v25
  buffer_load_dwordx2 v[8:9], v25, s[44:47], s60 offen offset:0
  buffer_load_dwordx2 v[10:11], v25, s[44:47], s60 offen offset:16
  buffer_load_dwordx2 v[12:13], v25, s[44:47], s60 offen offset:32
  buffer_load_dwordx2 v[14:15], v25, s[44:47], s60 offen offset:48
  buffer_load_dwordx4 v[16:19], v1, s[24:27], s96 offen sc1
  buffer_load_dwordx4 v[20:23], v1, s[24:27], s96 offen offset:1024 sc1
  s_add_u32 s60, s82, 512
  s_mov_b32 s61, 200000
L25:
  buffer_load_dword v24, v6, s[24:27], s60 offen sc1
DN26:
  s_sub_u32 s61, s61, 1
  s_cbranch_scc1 FIN
  s_waitcnt vmcnt(0)
  v_cmp_ne_u32 vcc, 0, v24
  s_and_b64 s[62:63], vcc, s[74:75]
  s_cmp_eq_u64 s[62:63], s[74:75]
  s_cbranch_scc0 L25
  s_cmp_lg_u32 s52, 0
  s_cbranch_scc1 SL27
DN28:
  s_mul_i32 s66, s50, 28672
  s_add_u32 s66, s66, 262144
  s_mul_i32 s64, s90, 114688
  s_add_u32 s64, s64, s66
  s_mul_i32 s65, s89, 114688
  s_add_u32 s65, s65, s66
  buffer_load_dwordx4 v[96:99], v1, s[24:27], s64 offen  sc1
  buffer_load_dwordx4 v[100:103], v1, s[24:27], s64 offen offset:1024 sc1
  buffer_load_dwordx4 v[104:107], v1, s[24:27], s64 offen offset:2048 sc1
  buffer_load_dwordx4 v[108:111], v1, s[24:27], s64 offen offset:3072 sc1
  s_add_u32 s64, s64, 4096
  buffer_load_dwordx4 v[112:115], v1, s[24:27], s64 offen  sc1
  buffer_load_dwordx4 v[116:119], v1, s[24:27], s64 offen offset:1024 sc1
  buffer_load_dwordx4 v[120:123], v1, s[24:27], s64 offen offset:2048 sc1
  buffer_load_dwordx4 v[124:127], v1, s[24:27], s64 offen offset:3072 sc1
  s_add_u32 s64, s64, 4096
  buffer_load_dwordx4 v[128:131], v1, s[24:27], s64 offen  sc1
  buffer_load_dwordx4 v[132:135], v1, s[24:27], s64 offen offset:1024 sc1
  s_xor_b32 s60, s50, 1
  s_mul_i32 s60, s60, 12288
  s_add_u32 s60, s60, 106496
  v_add_u32 v28, s60, v1
  s_xor_b32 s60, s50, 2
  s_mul_i32 s60, s60, 12288
  s_add_u32 s60, s60, 110592
  v_add_u32 v29, s60, v1
  s_xor_b32 s60, s50, 3
  s_mul_i32 s60, s60, 12288
  s_add_u32 s60, s60, 114688
  v_add_u32 v30, s60, v1
  s_mul_i32 s60, s50, 12288
  s_add_u32 s60, s60, 106496
  v_add_u32 v27, s60, v1
  v_lshlrev_b32 v80, 16, v16
  v_and_b32 v81, 0xffff0000, v16
  v_lshlrev_b32 v82, 16, v17
  v_and_b32 v83, 0xffff0000, v17
  v_lshlrev_b32 v84, 16, v18
  v_and_b32 v85, 0xffff0000, v18
  v_lshlrev_b32 v86, 16, v19
  v_and_b32 v87, 0xffff0000, v19
  v_lshlrev_b32 v88, 16, v20
  v_and_b32 v89, 0xffff0000, v20
  v_lshlrev_b32 v90, 16, v21
  v_and_b32 v91, 0xffff0000, v21
  v_lshlrev_b32 v92, 16, v22
  v_and_b32 v93, 0xffff0000, v22
  v_lshlrev_b32 v94, 16, v23
  v_and_b32 v95, 0xffff0000, v23
  v_dot2c_f32_bf16 v80, s91, v8
  v_dot2c_f32_bf16 v81, s92, v8
  v_dot2c_f32_bf16 v82, s91, v9
  v_dot2c_f32_bf16 v83, s92, v9
  v_dot2c_f32_bf16 v84, s91, v10
  v_dot2c_f32_bf16 v85, s92, v10
  v_dot2c_f32_bf16 v86, s91, v11
  v_dot2c_f32_bf16 v87, s92, v11
  v_dot2c_f32_bf16 v88, s91, v12
  v_dot2c_f32_bf16 v89, s92, v12
  v_dot2c_f32_bf16 v90, s91, v13
  v_dot2c_f32_bf16 v91, s92, v13
  v_dot2c_f32_bf16 v92, s91, v14
  v_dot2c_f32_bf16 v93, s92, v14
  v_dot2c_f32_bf16 v94, s91, v15
  v_dot2c_f32_bf16 v95, s92, v15
  s_add_u32 m0, s94, 65536
  s_mov_b32 s60, s95
  s_waitcnt vmcnt(9)
  v_mfma_f32_32x32x16_bf16 v[32:47], a[0:3], v[96:99], 0
  buffer_load_dwordx4 v[136:139], v1, s[24:27], s64 offen offset:2048 sc1
  v_mfma_f32_32x32x16_bf16 v[48:63], a[4:7], v[96:99], 0
  s_waitcnt vmcnt(9)
  v_mfma_f32_32x32x16_bf16 v[32:47], a[8:11], v[100:103], v[32:47]
  buffer_load_dwordx4 v[140:143], v1, s[24:27], s64 offen offset:3072 sc1
  v_mfma_f32_32x32x16_bf16 v[48:63], a[12:15], v[100:103], v[48:63]
  s_waitcnt vmcnt(9)
  v_mfma_f32_32x32x16_bf16 v[32:47], a[16:19], v[104:107], v[32:47]
  s_add_u32 s64, s64, 4096
  buffer_load_dwordx4 v[144:147], v1, s[24:27], s64 offen  sc1
  v_mfma_f32_32x32x16_bf16 v[48:63], a[20:23], v[104:107], v[48:63]
  s_waitcnt vmcnt(9)
  v_mfma_f32_32x32x16_bf16 v[32:47], a[24:27], v[108:111], v[32:47]
  buffer_load_dwordx4 v[148:151], v1, s[24:27], s64 offen offset:1024 sc1
  v_mfma_f32_32x32x16_bf16 v[48:63], a[28:31], v[108:111], v[48:63]
  s_waitcnt vmcnt(9)
  v_mfma_f32_32x32x16_bf16 v[32:47], a[32:35], v[112:115], v[32:47]
  buffer_load_dwordx4 v[152:155], v1, s[24:27], s64 offen offset:2048 sc1
  v_mfma_f32_32x32x16_bf16 v[48:63], a[36:39], v[112:115], v[48:63]
  s_waitcnt vmcnt(9)
  v_mfma_f32_32x32x16_bf16 v[32:47], a[40:43], v[116:119], v[32:47]
  buffer_load_dwordx4 v[156:159], v1, s[24:27], s64 offen offset:3072 sc1
  v_mfma_f32_32x32x16_bf16 v[48:63], a[44:47], v[116:119], v[48:63]
  s_waitcnt vmcnt(9)
  v_mfma_f32_32x32x16_bf16 v[32:47], a[48:51], v[120:123], v[32:47]
  s_add_u32 s64, s64, 4096
  buffer_load_dwordx4 v[160:163], v1, s[24:27], s64 offen  sc1
  v_mfma_f32_32x32x16_bf16 v[48:63], a[52:55], v[120:123], v[48:63]
  s_waitcnt vmcnt(9)
  v_mfma_f32_32x32x16_bf16 v[32:47], a[56:59], v[124:127], v[32:47]
  buffer_load_dwordx4 v[164:167], v1, s[24:27], s64 offen offset:1024 sc1
  v_mfma_f32_32x32x16_bf16 v[48:63], a[60:63], v[124:127], v[48:63]
  s_waitcnt vmcnt(9)
  v_mfma_f32_32x32x16_bf16 v[32:47], a[64:67], v[128:131], v[32:47]
  buffer_load_dwordx4 v[168:171], v1, s[24:27], s64 offen offset:2048 sc1
  v_mfma_f32_32x32x16_bf16 v[48:63], a[68:71], v[128:131], v[48:63]
  s_waitcnt vmcnt(9)
  v_mfma_f32_32x32x16_bf16 v[32:47], a[72:75], v[132:135], v[32:47]
  buffer_load_dwordx4 v[172:175], v1, s[24:27], s64 offen offset:3072 sc1
  v_mfma_f32_32x32x16_bf16 v[48:63], a[76:79], v[132:135], v[48:63]
  s_waitcnt vmcnt(9)
  v_mfma_f32_32x32x16_bf16 v[32:47], a[80:83], v[136:139], v[32:47]
  s_add_u32 s64, s64, 4096
  buffer_load_dwordx4 v[176:179], v1, s[24:27], s64 offen  sc1
  v_mfma_f32_32x32x16_bf16 v[48:63], a[84:87], v[136:139], v[48:63]
  s_waitcnt vmcnt(9)
  v_mfma_f32_32x32x16_bf16 v[32:47], a[88:91], v[140:143], v[32:47]
  buffer_load_dwordx4 v[180:183], v1, s[24:27], s64 offen offset:1024 sc1
  v_mfma_f32_32x32x16_bf16 v[48:63], a[92:95], v[140:143], v[48:63]
  s_waitcnt vmcnt(9)
  v_mfma_f32_32x32x16_bf16 v[32:47], a[96:99], v[144:147], v[32:47]
  buffer_load_dwordx4 v[184:187], v1, s[24:27], s64 offen offset:2048 sc1
  v_mfma_f32_32x32x16_bf16 v[48:63], a[100:103], v[144:147], v[48:63]
  s_waitcnt vmcnt(9)
  v_mfma_f32_32x32x16_bf16 v[32:47], a[104:107], v[148:151], v[32:47]
  buffer_load_dwordx4 v[188:191], v1, s[24:27], s64 offen offset:3072 sc1
  v_mfma_f32_32x32x16_bf16 v[48:63], a[108:111], v[148:151], v[48:63]
  s_waitcnt vmcnt(9)
  v_mfma_f32_32x32x16_bf16 v[32:47], a[112:115], v[152:155], v[32:47]
  s_add_u32 s64, s64, 4096
  buffer_load_dwordx4 v[192:195], v1, s[24:27], s64 offen  sc1
  v_mfma_f32_32x32x16_bf16 v[48:63], a[116:119], v[152:155], v[48:63]
  s_waitcnt vmcnt(9)
  v_mfma_f32_32x32x16_bf16 v[32:47], a[120:123], v[156:159], v[32:47]
  buffer_load_dwordx4 v[196:199], v1, s[24:27], s64 offen offset:1024 sc1
  v_mfma_f32_32x32x16_bf16 v[48:63], a[124:127], v[156:159], v[48:63]
  s_waitcnt vmcnt(9)
  v_mfma_f32_32x32x16_bf16 v[32:47], a[128:131], v[160:163], v[32:47]
  buffer_load_dwordx4 v[200:203], v1, s[24:27], s64 offen offset:2048 sc1
  v_mfma_f32_32x32x16_bf16 v[48:63], a[132:135], v[160:163], v[48:63]
  s_waitcnt vmcnt(9)
  v_mfma_f32_32x32x16_bf16 v[32:47], a[136:139], v[164:167], v[32:47]
  buffer_load_dwordx4 v[204:207], v1, s[24:27], s64 offen offset:3072 sc1
  v_mfma_f32_32x32x16_bf16 v[48:63], a[140:143], v[164:167], v[48:63]
  s_waitcnt vmcnt(9)
  v_mfma_f32_32x32x16_bf16 v[32:47], a[144:147], v[168:171], v[32:47]
  buffer_load_dwordx4 v[208:211], v1, s[24:27], s65 offen  sc1
  v_mfma_f32_32x32x16_bf16 v[48:63], a[148:151], v[168:171], v[48:63]
  s_waitcnt vmcnt(9)
  v_mfma_f32_32x32x16_bf16 v[32:47], a[152:155], v[172:175], v[32:47]
  buffer_load_dwordx4 v[212:215], v1, s[24:27], s65 offen offset:1024 sc1
  v_mfma_f32_32x32x16_bf16 v[48:63], a[156:159], v[172:175], v[48:63]
  s_waitcnt vmcnt(9)
  v_mfma_f32_32x32x16_bf16 v[32:47], a[160:163], v[176:179], v[32:47]
  buffer_load_dwordx4 v[216:219], v1, s[24:27], s65 offen offset:2048 sc1
  v_mfma_f32_32x32x16_bf16 v[48:63], a[164:167], v[176:179], v[48:63]
  s_waitcnt vmcnt(9)
  v_mfma_f32_32x32x16_bf16 v[32:47], a[168:171], v[180:183], v[32:47]
  buffer_load_dwordx4 v[220:223], v1, s[24:27], s65 offen offset:3072 sc1
  v_mfma_f32_32x32x16_bf16 v[48:63], a[172:175], v[180:183], v[48:63]
  s_waitcnt vmcnt(9)
  v_mfma_f32_32x32x16_bf16 v[32:47], a[176:179], v[184:187], v[32:47]
  s_add_u32 s65, s65, 4096
  buffer_load_dwordx4 v[96:99], v1, s[24:27], s65 offen  sc1
  v_mfma_f32_32x32x16_bf16 v[48:63], a[180:183], v[184:187], v[48:63]
  s_waitcnt vmcnt(9)
  v_mfma_f32_32x32x16_bf16 v[32:47], a[184:187], v[188:191], v[32:47]
  buffer_load_dwordx4 v[100:103], v1, s[24:27], s65 offen offset:1024 sc1
  v_mfma_f32_32x32x16_bf16 v[48:63], a[188:191], v[188:191], v[48:63]
  s_waitcnt vmcnt(9)
  v_mfma_f32_32x32x16_bf16 v[32:47], a[192:195], v[192:195], v[32:47]
  buffer_load_dwordx4 v[104:107], v1, s[24:27], s65 offen offset:2048 sc1
  v_mfma_f32_32x32x16_bf16 v[48:63], a[196:199], v[192:195], v[48:63]
  s_waitcnt vmcnt(9)
  v_mfma_f32_32x32x16_bf16 v[32:47], a[200:203], v[196:199], v[32:47]
  buffer_load_dwordx4 v[108:111], v1, s[24:27], s65 offen offset:3072 sc1
  v_mfma_f32_32x32x16_bf16 v[48:63], a[204:207], v[196:199], v[48:63]
  s_waitcnt vmcnt(9)
  v_mfma_f32_32x32x16_bf16 v[32:47], a[208:211], v[200:203], v[32:47]
  s_add_u32 s65, s65, 4096
  buffer_load_dwordx4 v[112:115], v1, s[24:27], s65 offen  sc1
  v_mfma_f32_32x32x16_bf16 v[48:63], a[212:215], v[200:203], v[48:63]
  s_waitcnt vmcnt(9)
  v_mfma_f32_32x32x16_bf16 v[32:47], a[216:219], v[204:207], v[32:47]
  buffer_load_dwordx4 v[116:119], v1, s[24:27], s65 offen offset:1024 sc1
  v_mfma_f32_32x32x16_bf16 v[48:63], a[220:223], v[204:207], v[48:63]
  s_waitcnt vmcnt(9)
  v_mfma_f32_32x32x16_bf16 v[64:79], a[4:7], v[208:211], 0
  buffer_load_dwordx4 v[120:123], v1, s[24:27], s65 offen offset:2048 sc1
  v_mfma_f32_32x32x16_bf16 v[80:95], a[0:3], v[208:211], v[80:95]
  s_waitcnt vmcnt(9)
  v_mfma_f32_32x32x16_bf16 v[64:79], a[12:15], v[212:215], v[64:79]
  buffer_load_dwordx4 v[124:127], v1, s[24:27], s65 offen offset:3072 sc1
  v_mfma_f32_32x32x16_bf16 v[80:95], a[8:11], v[212:215], v[80:95]
  s_waitcnt vmcnt(9)
  v_mfma_f32_32x32x16_bf16 v[64:79], a[20:23], v[216:219], v[64:79]
  ds_write_b128 v29, v[32:35] offset:0
  s_add_u32 s65, s65, 4096
  buffer_load_dwordx4 v[128:131], v1, s[24:27], s65 offen  sc1
  v_mfma_f32_32x32x16_bf16 v[80:95], a[16:19], v[216:219], v[80:95]
  ds_write_b128 v29, v[36:39] offset:1024
  s_waitcnt vmcnt(9)
  v_mfma_f32_32x32x16_bf16 v[64:79], a[28:31], v[220:223], v[64:79]
  ds_write_b128 v29, v[40:43] offset:2048
  buffer_load_dwordx4 v[132:135], v1, s[24:27], s65 offen offset:1024 sc1
  v_mfma_f32_32x32x16_bf16 v[80:95], a[24:27], v[220:223], v[80:95]
  ds_write_b128 v29, v[44:47] offset:3072
  s_waitcnt vmcnt(9)
  v_mfma_f32_32x32x16_bf16 v[64:79], a[36:39], v[96:99], v[64:79]
  ds_write_b128 v30, v[48:51] offset:0
  buffer_load_dwordx4 v[136:139], v1, s[24:27], s65 offen offset:2048 sc1
  v_mfma_f32_32x32x16_bf16 v[80:95], a[32:35], v[96:99], v[80:95]
  ds_write_b128 v30, v[52:55] offset:1024
  s_waitcnt vmcnt(9)
  v_mfma_f32_32x32x16_bf16 v[64:79], a[44:47], v[100:103], v[64:79]
  ds_write_b128 v30, v[56:59] offset:2048
  buffer_load_dwordx4 v[140:143], v1, s[24:27], s65 offen offset:3072 sc1
  v_mfma_f32_32x32x16_bf16 v[80:95], a[40:43], v[100:103], v[80:95]
  ds_write_b128 v30, v[60:63] offset:3072
  s_waitcnt vmcnt(9)
  v_mfma_f32_32x32x16_bf16 v[64:79], a[52:55], v[104:107], v[64:79]
  s_add_u32 s65, s65, 4096
  buffer_load_dwordx4 v[144:147], v1, s[24:27], s65 offen  sc1
  v_mfma_f32_32x32x16_bf16 v[80:95], a[48:51], v[104:107], v[80:95]
  s_waitcnt vmcnt(9)
  v_mfma_f32_32x32x16_bf16 v[64:79], a[60:63], v[108:111], v[64:79]
  buffer_load_dwordx4 v[148:151], v1, s[24:27], s65 offen offset:1024 sc1
  v_mfma_f32_32x32x16_bf16 v[80:95], a[56:59], v[108:111], v[80:95]
  s_waitcnt vmcnt(9)
  v_mfma_f32_32x32x16_bf16 v[64:79], a[68:71], v[112:115], v[64:79]
  buffer_load_dwordx4 v[152:155], v1, s[24:27], s65 offen offset:2048 sc1
  v_mfma_f32_32x32x16_bf16 v[80:95], a[64:67], v[112:115], v[80:95]
  s_waitcnt vmcnt(9)
  v_mfma_f32_32x32x16_bf16 v[64:79], a[76:79], v[116:119], v[64:79]
  buffer_load_dwordx4 v[156:159], v1, s[24:27], s65 offen offset:3072 sc1
  v_mfma_f32_32x32x16_bf16 v[80:95], a[72:75], v[116:119], v[80:95]
  s_waitcnt vmcnt(9)
  v_mfma_f32_32x32x16_bf16 v[64:79], a[84:87], v[120:123], v[64:79]
  s_add_u32 s65, s65, 4096
  buffer_load_dwordx4 v[160:163], v1, s[24:27], s65 offen  sc1
  v_mfma_f32_32x32x16_bf16 v[80:95], a[80:83], v[120:123], v[80:95]
  s_waitcnt vmcnt(9)
  v_mfma_f32_32x32x16_bf16 v[64:79], a[92:95], v[124:127], v[64:79]
  buffer_load_dwordx4 v[164:167], v1, s[24:27], s65 offen offset:1024 sc1
  v_mfma_f32_32x32x16_bf16 v[80:95], a[88:91], v[124:127], v[80:95]
  s_waitcnt vmcnt(9)
  v_mfma_f32_32x32x16_bf16 v[64:79], a[100:103], v[128:131], v[64:79]
  buffer_load_dwordx4 v[168:171], v1, s[24:27], s65 offen offset:2048 sc1
  v_mfma_f32_32x32x16_bf16 v[80:95], a[96:99], v[128:131], v[80:95]
  s_waitcnt vmcnt(9)
  v_mfma_f32_32x32x16_bf16 v[64:79], a[108:111], v[132:135], v[64:79]
  buffer_load_dwordx4 v[172:175], v1, s[24:27], s65 offen offset:3072 sc1
  v_mfma_f32_32x32x16_bf16 v[80:95], a[104:107], v[132:135], v[80:95]
  s_waitcnt vmcnt(9)
  v_mfma_f32_32x32x16_bf16 v[64:79], a[116:119], v[136:139], v[64:79]
  s_add_u32 s65, s65, 4096
  buffer_load_dwordx4 v[176:179], v1, s[24:27], s65 offen  sc1
  v_mfma_f32_32x32x16_bf16 v[80:95], a[112:115], v[136:139], v[80:95]
  s_waitcnt vmcnt(9)
  v_mfma_f32_32x32x16_bf16 v[64:79], a[124:127], v[140:143], v[64:79]
  buffer_load_dwordx4 v[180:183], v1, s[24:27], s65 offen offset:1024 sc1
  v_mfma_f32_32x32x16_bf16 v[80:95], a[120:123], v[140:143], v[80:95]
  s_waitcnt vmcnt(9)
  v_mfma_f32_32x32x16_bf16 v[64:79], a[132:135], v[144:147], v[64:79]
  buffer_load_dwordx4 v[184:187], v1, s[24:27], s65 offen offset:2048 sc1
  v_mfma_f32_32x32x16_bf16 v[80:95], a[128:131], v[144:147], v[80:95]
  s_waitcnt vmcnt(9)
  v_mfma_f32_32x32x16_bf16 v[64:79], a[140:143], v[148:151], v[64:79]
  buffer_load_dwordx4 v[188:191], v1, s[24:27], s65 offen offset:3072 sc1
  v_mfma_f32_32x32x16_bf16 v[80:95], a[136:139], v[148:151], v[80:95]
  s_waitcnt vmcnt(9)
  v_mfma_f32_32x32x16_bf16 v[64:79], a[148:151], v[152:155], v[64:79]
  buffer_load_dwordx4 v4, s[8:11], s60 offen nt lds
  s_add_u32 m0, m0, 1024
  s_add_u32 s60, s60, 49152
  v_mfma_f32_32x32x16_bf16 v[80:95], a[144:147], v[152:155], v[80:95]
  s_waitcnt vmcnt(9)
  v_mfma_f32_32x32x16_bf16 v[64:79], a[156:159], v[156:159], v[64:79]
  buffer_load_dwordx4 v4, s[8:11], s60 offen nt lds
  s_add_u32 m0, m0, 1024
  s_add_u32 s60, s60, 49152
  v_mfma_f32_32x32x16_bf16 v[80:95], a[152:155], v[156:159], v[80:95]
  s_waitcnt vmcnt(9)
  v_mfma_f32_32x32x16_bf16 v[64:79], a[164:167], v[160:163], v[64:79]
  buffer_load_dwordx4 v4, s[8:11], s60 offen nt lds
  s_add_u32 m0, m0, 1024
  s_add_u32 s60, s60, 49152
  v_mfma_f32_32x32x16_bf16 v[80:95], a[160:163], v[160:163], v[80:95]
  s_waitcnt vmcnt(9)
  v_mfma_f32_32x32x16_bf16 v[64:79], a[172:175], v[164:167], v[64:79]
  buffer_load_dwordx4 v4, s[8:11], s60 offen nt lds
  s_add_u32 m0, m0, 1024
  s_add_u32 s60, s60, 49152
  v_mfma_f32_32x32x16_bf16 v[80:95], a[168:171], v[164:167], v[80:95]
  s_waitcnt vmcnt(9)
  v_mfma_f32_32x32x16_bf16 v[64:79], a[180:183], v[168:171], v[64:79]
  buffer_load_dwordx4 v4, s[8:11], s60 offen nt lds
  s_add_u32 m0, m0, 1024
  s_add_u32 s60, s60, 49152
  v_mfma_f32_32x32x16_bf16 v[80:95], a[176:179], v[168:171], v[80:95]
  s_waitcnt vmcnt(9)
  v_mfma_f32_32x32x16_bf16 v[64:79], a[188:191], v[172:175], v[64:79]
  buffer_load_dwordx4 v4, s[8:11], s60 offen nt lds
  s_add_u32 m0, m0, 1024
  s_add_u32 s60, s60, 49152
  v_mfma_f32_32x32x16_bf16 v[80:95], a[184:187], v[172:175], v[80:95]
  s_waitcnt vmcnt(9)
  v_mfma_f32_32x32x16_bf16 v[64:79], a[196:199], v[176:179], v[64:79]
  buffer_load_dwordx4 v4, s[8:11], s60 offen nt lds
  s_add_u32 m0, m0, 1024
  s_add_u32 s60, s60, 49152
  v_mfma_f32_32x32x16_bf16 v[80:95], a[192:195], v[176:179], v[80:95]
  s_waitcnt vmcnt(9)
  v_mfma_f32_32x32x16_bf16 v[64:79], a[204:207], v[180:183], v[64:79]
  buffer_load_dwordx4 v4, s[8:11], s60 offen nt lds
  s_add_u32 m0, m0, 1024
  s_add_u32 s60, s60, 49152
  v_mfma_f32_32x32x16_bf16 v[80:95], a[200:203], v[180:183], v[80:95]
  s_waitcnt vmcnt(9)
  v_mfma_f32_32x32x16_bf16 v[64:79], a[212:215], v[184:187], v[64:79]
  v_mfma_f32_32x32x16_bf16 v[80:95], a[208:211], v[184:187], v[80:95]
  s_waitcnt vmcnt(8)
  v_mfma_f32_32x32x16_bf16 v[64:79], a[220:223], v[188:191], v[64:79]
  v_mfma_f32_32x32x16_bf16 v[80:95], a[216:219], v[188:191], v[80:95]
  s_nop 7
  s_nop 2
  ds_write_b128 v28, v[64:67] offset:0
  ds_write_b128 v28, v[68:71] offset:1024
  ds_write_b128 v28, v[72:75] offset:2048
  ds_write_b128 v28, v[76:79] offset:3072
  s_waitcnt lgkmcnt(0)
  s_barrier
  ds_read_b128 v[32:35], v27 offset:0
  ds_read_b128 v[36:39], v27 offset:1024
  ds_read_b128 v[40:43], v27 offset:2048
  ds_read_b128 v[44:47], v27 offset:3072
  ds_read_b128 v[48:51], v27 offset:4096
  ds_read_b128 v[52:55], v27 offset:5120
  ds_read_b128 v[56:59], v27 offset:6144
  ds_read_b128 v[60:63], v27 offset:7168
  ds_read_b128 v[64:67], v27 offset:8192
  ds_read_b128 v[68:71], v27 offset:9216
  ds_read_b128 v[72:75], v27 offset:10240
  ds_read_b128 v[76:79], v27 offset:11264
  s_waitcnt lgkmcnt(11)
  v_pk_add_f32 v[80:81], v[80:81], v[32:33]
  v_pk_add_f32 v[82:83], v[82:83], v[34:35]
  s_waitcnt lgkmcnt(10)
  v_pk_add_f32 v[84:85], v[84:85], v[36:37]
  v_pk_add_f32 v[86:87], v[86:87], v[38:39]
  s_waitcnt lgkmcnt(9)
  v_pk_add_f32 v[88:89], v[88:89], v[40:41]
  v_pk_add_f32 v[90:91], v[90:91], v[42:43]
  s_waitcnt lgkmcnt(8)
  v_pk_add_f32 v[92:93], v[92:93], v[44:45]
  v_pk_add_f32 v[94:95], v[94:95], v[46:47]
  s_waitcnt lgkmcnt(7)
  v_pk_add_f32 v[80:81], v[80:81], v[48:49]
  v_pk_add_f32 v[82:83], v[82:83], v[50:51]
  s_waitcnt lgkmcnt(6)
  v_pk_add_f32 v[84:85], v[84:85], v[52:53]
  v_pk_add_f32 v[86:87], v[86:87], v[54:55]
  s_waitcnt lgkmcnt(5)
  v_pk_add_f32 v[88:89], v[88:89], v[56:57]
  v_pk_add_f32 v[90:91], v[90:91], v[58:59]
  s_waitcnt lgkmcnt(4)
  v_pk_add_f32 v[92:93], v[92:93], v[60:61]
  v_pk_add_f32 v[94:95], v[94:95], v[62:63]
  s_waitcnt lgkmcnt(3)
  v_pk_add_f32 v[80:81], v[80:81], v[64:65]
  v_pk_add_f32 v[82:83], v[82:83], v[66:67]
  s_waitcnt lgkmcnt(2)
  v_pk_add_f32 v[84:85], v[84:85], v[68:69]
  v_pk_add_f32 v[86:87], v[86:87], v[70:71]
  s_waitcnt lgkmcnt(1)
  v_pk_add_f32 v[88:89], v[88:89], v[72:73]
  v_pk_add_f32 v[90:91], v[90:91], v[74:75]
  s_waitcnt lgkmcnt(0)
  v_pk_add_f32 v[92:93], v[92:93], v[76:77]
  v_pk_add_f32 v[94:95], v[94:95], v[78:79]
  v_cvt_pk_bf16_f32 v16, v80, v81
  v_cvt_pk_bf16_f32 v17, v82, v83
  v_cvt_pk_bf16_f32 v18, v84, v85
  v_cvt_pk_bf16_f32 v19, v86, v87
  v_cvt_pk_bf16_f32 v20, v88, v89
  v_cvt_pk_bf16_f32 v21, v90, v91
  v_cvt_pk_bf16_f32 v22, v92, v93
  v_cvt_pk_bf16_f32 v23, v94, v95
  s_cmp_lg_u32 s51, 0
  s_cbranch_scc1 LAST
  buffer_store_dwordx4 v[16:19], v1, s[24:27], s96 offen
  buffer_store_dwordx4 v[20:23], v1, s[24:27], s96 offen offset:1024
  v_mov_b32 v24, 0
  v_mov_b32 v25, 0
  v_mov_b32 v26, 0
  v_mov_b32 v27, 0
  v_dot2c_f32_bf16 v24, s93, v16
  v_dot2c_f32_bf16 v25, v16, v16
  v_dot2c_f32_bf16 v26, s93, v17
  v_dot2c_f32_bf16 v27, v17, v17
  v_dot2c_f32_bf16 v24, s93, v18
  v_dot2c_f32_bf16 v25, v18, v18
  v_dot2c_f32_bf16 v26, s93, v19
  v_dot2c_f32_bf16 v27, v19, v19
  v_dot2c_f32_bf16 v24, s93, v20
  v_dot2c_f32_bf16 v25, v20, v20
  v_dot2c_f32_bf16 v26, s93, v21
  v_dot2c_f32_bf16 v27, v21, v21
  v_dot2c_f32_bf16 v24, s93, v22
  v_dot2c_f32_bf16 v25, v22, v22
  v_dot2c_f32_bf16 v26, s93, v23
  v_dot2c_f32_bf16 v27, v23, v23
  s_nop 2
  v_pk_add_f32 v[24:25], v[24:25], v[26:27]
  v_mov_b32 v26, v24
  v_mov_b32 v27, v25
  s_nop 0
  v_permlane32_swap_b32 v24, v26
  v_permlane32_swap_b32 v25, v27
  s_nop 1
  v_pk_add_f32 v[24:25], v[24:25], v[26:27]
  s_mov_b64 exec, s[78:79]
  buffer_store_dwordx2 v[24:25], v1, s[24:27], s97 offen
  s_mov_b64 exec, -1
  s_add_u32 s60, s83, 768
  s_cmp_lg_u32 s52, 0
  s_waitcnt vmcnt(0)
  s_mov_b64 exec, 1
  s_cbranch_scc1 SL29
  buffer_store_dword v3, off, s[24:27], s60
DN30:
  s_mov_b64 exec, -1
  s_barrier
  s_add_u32 s60, s82, 768
  s_mov_b32 s61, 200000
L31:
  buffer_load_dword v24, v6, s[24:27], s60 offen sc1
DN32:
  s_sub_u32 s61, s61, 1
  s_cbranch_scc1 FIN
  s_waitcnt vmcnt(0)
  v_cmp_ne_u32 vcc, 0, v24
  s_and_b64 s[62:63], vcc, s[70:71]
  s_cmp_eq_u64 s[62:63], s[70:71]
  s_cbranch_scc0 L31
  s_cmp_lg_u32 s52, 0
  s_cbranch_scc1 SL33
DN34:
  s_mov_b32 s51, 1
  s_add_u32 s82, s82, 1024
  s_add_u32 s83, s83, 1024
  s_add_u32 s86, s86, 294912
  s_branch LAYER
LAST:
  v_and_b32 v30, 0x1f0, v1
  v_lshlrev_b32 v30, 6, v30
  v_lshrrev_b32 v25, 5, v1
  v_and_or_b32 v30, v25, 16, v30
  v_permlane32_swap_b32 v16, v18
  v_permlane32_swap_b32 v17, v19
  v_permlane32_swap_b32 v20, v22
  v_permlane32_swap_b32 v21, v23
  s_nop 1
  buffer_store_dwordx4 v[16:19], v30, s[32:35], s68 offen
  buffer_store_dwordx4 v[20:23], v30, s[32:35], s68 offen offset:32
FIN:
END:
  s_endpgm
SL8:
  buffer_wbl2 sc1
  s_waitcnt vmcnt(0)
  buffer_store_dword v3, off, s[24:27], s60 sc0 sc1
  s_branch DN9
SL12:
  buffer_inv sc1
  s_branch DN13
SL14:
  buffer_wbl2 sc1
  s_waitcnt vmcnt(0)
  buffer_store_dword v3, off, s[24:27], s60 sc0 sc1
  s_branch DN15
SL19:
  buffer_inv sc1
  s_branch DN20
SL21:
  buffer_wbl2 sc1
  s_waitcnt vmcnt(0)
  buffer_store_dword v3, off, s[24:27], s60 sc0 sc1
  s_branch DN22
SKIP3:
  v_lshrrev_b32 v24, 7, v1
  v_mul_u32_u24 v24, 3072, v24
  v_and_b32 v25, 0x70, v1
  v_lshl_add_u32 v24, v25, 3, v24
  s_and_b32 s64, s48, 1
  s_lshl_b32 s64, s64, 1
  s_add_u32 s64, s64, s49
  s_sub_u32 s64, s64, 14
  s_lshl_b32 s64, s64, 2
  s_add_u32 s64, s64, s50
  s_mul_i32 s59, s64, 114688
  s_mul_i32 s64, s64, 98304
  s_add_u32 s65, s64, 24576
  s_add_u32 s66, s64, 49152
  s_add_u32 s67, s64, 73728
  buffer_load_dword v96, v24, s[8:11], s64 offen offset:1024
  buffer_load_dword v96, v24, s[8:11], s65 offen offset:1024
  buffer_load_dword v96, v24, s[8:11], s66 offen offset:1024
  buffer_load_dword v96, v24, s[8:11], s67 offen offset:1024
  buffer_load_dword v96, v24, s[8:11], s64 offen offset:2048
  buffer_load_dword v96, v24, s[8:11], s65 offen offset:2048
  buffer_load_dword v96, v24, s[8:11], s66 offen offset:2048
  buffer_load_dword v96, v24, s[8:11], s67 offen offset:2048
  s_add_u32 s62, s94, 0
  s_add_u32 s63, s95, 1024
  s_mov_b32 m0, s62
  s_mov_b32 s60, s63
  s_add_u32 s61, s60, 393216
L23:
  buffer_load_dwordx4 v4, s[8:11], s60 offen nt lds
  s_add_u32 m0, m0, 1024
  s_add_u32 s60, s60, 49152
  s_cmp_lg_u32 s60, s61
  s_cbranch_scc1 L23
  s_add_u32 s62, s94, 32768
  s_add_u32 s63, s95, 2048
  s_mov_b32 m0, s62
  s_mov_b32 s60, s63
  s_add_u32 s61, s60, 393216
L24:
  buffer_load_dwordx4 v4, s[8:11], s60 offen nt lds
  s_add_u32 m0, m0, 1024
  s_add_u32 s60, s60, 49152
  s_cmp_lg_u32 s60, s61
  s_cbranch_scc1 L24
  v_lshlrev_b32 v24, 4, v1
  s_cmp_eq_u32 s51, 0
  s_cselect_b32 s18, 1835008, 0
  s_add_u32 s60, s59, 0
  buffer_load_dword v96, v24, s[16:19], s60 offen offset:0
  s_add_u32 s60, s59, 16384
  buffer_load_dword v96, v24, s[16:19], s60 offen offset:0
  s_add_u32 s60, s59, 32768
  buffer_load_dword v96, v24, s[16:19], s60 offen offset:0
  s_add_u32 s60, s59, 49152
  buffer_load_dword v96, v24, s[16:19], s60 offen offset:0
  s_mov_b32 s18, 0
  s_branch P4
SL27:
  buffer_inv sc1
  s_branch DN28
SL29:
  buffer_wbl2 sc1
  s_waitcnt vmcnt(0)
  buffer_store_dword v3, off, s[24:27], s60 sc0 sc1
  s_branch DN30
SL33:
  buffer_inv sc1
  s_branch DN34
s_endpgm
.section .rodata,"a"
.p2align 6
.amdhsa_kernel interleave_layers__linear_attn_block__mixer_channel_mlp__prompt_kernel
  .amdhsa_next_free_vgpr 512
  .amdhsa_next_free_sgpr 102
  .amdhsa_accum_offset 256
  .amdhsa_group_segment_fixed_size 0
  .amdhsa_kernarg_size 88
  .amdhsa_user_sgpr_count 2
  .amdhsa_user_sgpr_kernarg_segment_ptr 1
  .amdhsa_system_sgpr_workgroup_id_x 1
.end_amdhsa_kernel
```
